```python
import torch

def _softmax(x, axis=-1):
    return torch.softmax(x, dim=axis)
def _gelu(x):
    return torch.nn.functional.gelu(x, approximate="tanh")
def _silu(x):
    return torch.nn.functional.silu(x)
def _sigmoid(x):
    return torch.sigmoid(x)
def _layernorm(x, axis=-1, eps=1e-5):
    m = x.mean(dim=axis, keepdim=True)
    v = x.var(dim=axis, keepdim=True, unbiased=False)
    return (x - m) / torch.sqrt(v + eps)
def _scatter_add(tgt, idx, src, axis=0):
    return tgt.clone().index_add_(axis, idx, src)
def _segment_sum(src, seg, n):
    out = torch.zeros((n,) + src.shape[1:], dtype=src.dtype)
    return out.index_add_(0, seg, src)
def _pad(x, pw):
    flat = tuple(v for pair in reversed(pw) for v in pair)
    return torch.nn.functional.pad(x, flat)

kernel_name = 'standalone__dense_activation_silu__sampling'

def setup_inputs():

    _w = (lambda a: (lambda t: t.to(torch.bfloat16) if t.is_floating_point() else t)(torch.as_tensor(a)))
    B, S, D, F = 16, 32, 576, 4608
    return {
        "x": _w((lambda *s: torch.randn(*s, dtype=torch.bfloat16) * 0.1)(B, S, D)),
        "w1": _w((lambda *s: torch.randn(*s, dtype=torch.bfloat16) * 3.2)(D, F) * (D ** -0.5)),
        "w2": _w((lambda *s: torch.randn(*s, dtype=torch.bfloat16) * 3.2)(F, D) * (F ** -0.5)),
    }

def reference(x, w1, w2):
    h = torch.einsum("bsd,df->bsf", x, w1)
    h = _silu(h)
    out = torch.einsum("bsf,fd->bsd", h, w2)
    return out
```

```asm
; @launch grid=(256,1,1) block=(512,1,1) lds=163840
.amdgcn_target "amdgcn-amd-amdhsa--gfx950"
.text
.globl standalone__dense_activation_silu__sampling_kernel
.p2align 8
.type standalone__dense_activation_silu__sampling_kernel,@function
standalone__dense_activation_silu__sampling_kernel:
s_cmp_ge_u32 s2, 256
s_cbranch_scc1 L_end
s_load_dwordx4 s[4:7], s[0:1], 0
s_load_dwordx4 s[8:11], s[0:1], 16
s_load_dwordx2 s[12:13], s[0:1], 40
s_getpc_b64 s[22:23]
L_pf:
v_lshlrev_b32 v1, 7, v0
v_min_u32 v1, L_end-L_pf, v1
global_load_dword v31, v1, s[22:23]
v_lshrrev_b32 v1, 6, v0
s_and_b32 s14, s2, 7
s_lshr_b32 s3, s2, 3
v_readfirstlane_b32 s17, v1
s_cmp_ge_u32 s2, 192
s_cbranch_scc1 L_prefetch
s_mul_i32 s15, s3, 171
s_lshr_b32 s15, s15, 9
s_mul_i32 s16, s15, 3
s_sub_u32 s16, s3, s16
v_and_b32 v0, 63, v0
s_cmp_lt_u32 s17, 4
s_cbranch_scc1 L_compute
s_cmp_eq_u32 s17, 7
s_cbranch_scc1 L_control
s_sub_u32 s62, s17, 4
v_lshrrev_b32 v1, 3, v0
v_and_b32 v2, 7, v0
v_lshrrev_b32 v6, 1, v1
v_mul_u32_u24 v5, 1152, v1
v_xor_b32 v6, v2, v6
v_lshlrev_b32 v7, 4, v6
v_add_u32 v8, v5, v7
v_xor_b32 v7, 64, v7
v_add_u32 v9, v5, v7
v_add_u32 v9, 8192, v9
v_add_u32 v10, 16384, v8
v_add_u32 v11, 16384, v9
s_mul_i32 s22, s16, 3
s_add_u32 s22, s22, s15
s_add_u32 s22, s22, s62
s_cmp_ge_u32 s22, 9
s_cselect_b32 s23, 9, 0
s_sub_u32 s48, s22, s23
s_mul_i32 s22, s15, 73728
s_lshl_b32 s51, s48, 7
s_add_u32 s51, s51, s22
s_lshl_b32 s63, s62, 13
v_and_b32 v3, 2, v1
v_lshlrev_b32 v3, 1, v3
v_xor_b32 v3, v2, v3
v_lshlrev_b32 v3, 4, v3
v_mul_u32_u24 v4, 9216, v1
v_add_u32 v12, v4, v3
v_add_u32 v16, v5, v3
s_mul_i32 s23, s14, 1152
s_mul_i32 s3, s16, 384
s_add_u32 s23, s23, s3
s_mul_i32 s3, s48, 589824
s_add_u32 s54, s23, s3
v_add_u32 v13, 72704, v12
v_add_u32 v14, 145408, v12
v_add_u32 v15, 218112, v12
s_waitcnt lgkmcnt(0)
s_mov_b32 s24, s4
s_and_b32 s25, s5, 0xffff
s_mov_b32 s26, 589824
s_mov_b32 s27, 0x20000
s_add_u32 m0, s63, 0
s_add_u32 s61, s51, 36864
buffer_load_dwordx4 v8, s[24:27], s51 offen offset:0  lds
buffer_load_dwordx4 v9, s[24:27], s51 offen offset:1024  lds
buffer_load_dwordx4 v10, s[24:27], s51 offen offset:2048  lds
buffer_load_dwordx4 v11, s[24:27], s51 offen offset:3072  lds
s_add_u32 m0, s63, 4096
s_nop 0
buffer_load_dwordx4 v8, s[24:27], s61 offen offset:0  lds
buffer_load_dwordx4 v9, s[24:27], s61 offen offset:1024  lds
buffer_load_dwordx4 v10, s[24:27], s61 offen offset:2048  lds
buffer_load_dwordx4 v11, s[24:27], s61 offen offset:3072  lds
s_mov_b32 s28, s6
s_and_b32 s29, s7, 0xffff
s_mov_b32 s30, 5308416
s_mov_b32 s31, 0x20000
s_add_u32 m0, s63, 73728
s_add_u32 s61, s54, 294912
buffer_load_dwordx4 v12, s[28:31], s54 offen offset:0 nt lds
buffer_load_dwordx4 v13, s[28:31], s54 offen offset:1024 nt lds
buffer_load_dwordx4 v14, s[28:31], s54 offen offset:2048 nt lds
buffer_load_dwordx4 v15, s[28:31], s54 offen offset:3072 nt lds
s_add_u32 m0, s63, 77824
s_nop 0
buffer_load_dwordx4 v12, s[28:31], s61 offen offset:0 nt lds
buffer_load_dwordx4 v13, s[28:31], s61 offen offset:1024 nt lds
buffer_load_dwordx4 v14, s[28:31], s61 offen offset:2048 nt lds
buffer_load_dwordx4 v15, s[28:31], s61 offen offset:3072 nt lds
s_add_u32 s3, s48, 3
s_cmp_ge_u32 s3, 9
s_cselect_b32 s49, 9, 0
s_sub_u32 s49, s3, s49
s_lshl_b32 s3, s49, 7
s_add_u32 s52, s22, s3
s_mul_i32 s3, s49, 589824
s_add_u32 s55, s23, s3
s_add_u32 m0, s63, 24576
s_add_u32 s61, s52, 36864
buffer_load_dwordx4 v8, s[24:27], s52 offen offset:0  lds
buffer_load_dwordx4 v9, s[24:27], s52 offen offset:1024  lds
buffer_load_dwordx4 v10, s[24:27], s52 offen offset:2048  lds
buffer_load_dwordx4 v11, s[24:27], s52 offen offset:3072  lds
s_add_u32 m0, s63, 28672
s_nop 0
buffer_load_dwordx4 v8, s[24:27], s61 offen offset:0  lds
buffer_load_dwordx4 v9, s[24:27], s61 offen offset:1024  lds
buffer_load_dwordx4 v10, s[24:27], s61 offen offset:2048  lds
buffer_load_dwordx4 v11, s[24:27], s61 offen offset:3072  lds
s_add_u32 m0, s63, 98304
s_add_u32 s61, s55, 294912
buffer_load_dwordx4 v12, s[28:31], s55 offen offset:0 nt lds
buffer_load_dwordx4 v13, s[28:31], s55 offen offset:1024 nt lds
buffer_load_dwordx4 v14, s[28:31], s55 offen offset:2048 nt lds
buffer_load_dwordx4 v15, s[28:31], s55 offen offset:3072 nt lds
s_add_u32 m0, s63, 102400
s_nop 0
buffer_load_dwordx4 v12, s[28:31], s61 offen offset:0 nt lds
buffer_load_dwordx4 v13, s[28:31], s61 offen offset:1024 nt lds
buffer_load_dwordx4 v14, s[28:31], s61 offen offset:2048 nt lds
buffer_load_dwordx4 v15, s[28:31], s61 offen offset:3072 nt lds
s_add_u32 s3, s49, 3
s_cmp_ge_u32 s3, 9
s_cselect_b32 s50, 9, 0
s_sub_u32 s50, s3, s50
s_lshl_b32 s3, s50, 7
s_add_u32 s53, s22, s3
s_mul_i32 s3, s50, 589824
s_add_u32 s56, s23, s3
s_add_u32 s44, s16, 1
s_cmp_eq_u32 s44, 3
s_cselect_b32 s44, 0, s44
s_add_u32 s45, s44, 1
s_cmp_eq_u32 s45, 3
s_cselect_b32 s45, 0, s45
s_lshl_b32 s18, s14, 3
s_add_u32 s18, s18, s15
s_mul_i32 s18, s18, 3
s_add_u32 s18, s18, s16
s_lshl_b32 s3, s15, 7
s_mov_b32 s32, s8
s_and_b32 s33, s9, 0xffff
s_mov_b32 s34, 5308416
s_mov_b32 s35, 0x20000
v_add_u32 v17, 8192, v16
v_add_u32 v18, 16384, v16
v_add_u32 v19, 24576, v16
s_mul_i32 s22, s14, 663552
s_mul_i32 s23, s16, 384
s_add_u32 s22, s22, s23
s_mul_i32 s3, s16, 221184
s_add_u32 s57, s22, s3
s_mul_i32 s3, s44, 221184
s_add_u32 s58, s22, s3
s_mul_i32 s3, s45, 221184
s_add_u32 s59, s22, s3
s_cmp_eq_u32 s62, 1
s_cselect_b32 s3, s44, s16
s_cmp_eq_u32 s62, 2
s_cselect_b32 s3, s45, s3
s_sub_u32 s47, s18, s16
s_add_u32 s47, s47, s3
s_mul_i32 s47, s47, 24576
s_add_u32 s47, s47, 262144
v_lshlrev_b32 v20, 4, v0
s_lshl_b32 s3, s15, 7
s_load_dwordx2 s[20:21], s[12:13], s3
s_mov_b32 s36, s12
s_and_b32 s37, s13, 0xffff
s_mov_b32 s38, 268435456
s_mov_b32 s39, 0x20000
s_mov_b32 s40, s10
s_and_b32 s41, s11, 0xffff
s_mov_b32 s42, 589824
s_mov_b32 s43, 0x20000
s_waitcnt lgkmcnt(0)
s_add_u32 s20, s20, 0x7f4a7c15
s_addc_u32 s21, s21, 0x9e3779b9
s_cmp_eq_u32 s62, 1
s_cbranch_scc1 L_loader1
s_cmp_eq_u32 s62, 2
s_cbranch_scc1 L_loader2
L_loader0:
s_waitcnt vmcnt(16)
s_barrier
s_mov_b32 m0, 49152
s_add_u32 s61, s53, 36864
buffer_load_dwordx4 v8, s[24:27], s53 offen offset:0  lds
buffer_load_dwordx4 v9, s[24:27], s53 offen offset:1024  lds
buffer_load_dwordx4 v10, s[24:27], s53 offen offset:2048  lds
buffer_load_dwordx4 v11, s[24:27], s53 offen offset:3072  lds
s_mov_b32 m0, 53248
s_nop 0
buffer_load_dwordx4 v8, s[24:27], s61 offen offset:0  lds
buffer_load_dwordx4 v9, s[24:27], s61 offen offset:1024  lds
buffer_load_dwordx4 v10, s[24:27], s61 offen offset:2048  lds
buffer_load_dwordx4 v11, s[24:27], s61 offen offset:3072  lds
s_add_u32 s60, s56, 0
s_mov_b32 m0, 122880
s_add_u32 s61, s60, 294912
buffer_load_dwordx4 v12, s[28:31], s60 offen offset:0 nt lds
buffer_load_dwordx4 v13, s[28:31], s60 offen offset:1024 nt lds
buffer_load_dwordx4 v14, s[28:31], s60 offen offset:2048 nt lds
buffer_load_dwordx4 v15, s[28:31], s60 offen offset:3072 nt lds
s_mov_b32 m0, 126976
s_nop 0
buffer_load_dwordx4 v12, s[28:31], s61 offen offset:0 nt lds
buffer_load_dwordx4 v13, s[28:31], s61 offen offset:1024 nt lds
buffer_load_dwordx4 v14, s[28:31], s61 offen offset:2048 nt lds
buffer_load_dwordx4 v15, s[28:31], s61 offen offset:3072 nt lds
s_waitcnt vmcnt(16)
s_barrier
s_add_u32 s60, s54, 128
s_mov_b32 m0, 147456
s_add_u32 s61, s60, 294912
buffer_load_dwordx4 v12, s[28:31], s60 offen offset:0 nt lds
buffer_load_dwordx4 v13, s[28:31], s60 offen offset:1024 nt lds
buffer_load_dwordx4 v14, s[28:31], s60 offen offset:2048 nt lds
buffer_load_dwordx4 v15, s[28:31], s60 offen offset:3072 nt lds
s_mov_b32 m0, 151552
s_nop 0
buffer_load_dwordx4 v12, s[28:31], s61 offen offset:0 nt lds
buffer_load_dwordx4 v13, s[28:31], s61 offen offset:1024 nt lds
buffer_load_dwordx4 v14, s[28:31], s61 offen offset:2048 nt lds
buffer_load_dwordx4 v15, s[28:31], s61 offen offset:3072 nt lds
s_add_u32 s60, s55, 128
s_mov_b32 m0, 81920
s_add_u32 s61, s60, 294912
buffer_load_dwordx4 v12, s[28:31], s60 offen offset:0 nt lds
buffer_load_dwordx4 v13, s[28:31], s60 offen offset:1024 nt lds
buffer_load_dwordx4 v14, s[28:31], s60 offen offset:2048 nt lds
buffer_load_dwordx4 v15, s[28:31], s60 offen offset:3072 nt lds
s_mov_b32 m0, 86016
s_nop 0
buffer_load_dwordx4 v12, s[28:31], s61 offen offset:0 nt lds
buffer_load_dwordx4 v13, s[28:31], s61 offen offset:1024 nt lds
buffer_load_dwordx4 v14, s[28:31], s61 offen offset:2048 nt lds
buffer_load_dwordx4 v15, s[28:31], s61 offen offset:3072 nt lds
s_waitcnt vmcnt(16)
s_barrier
s_add_u32 s60, s56, 128
s_mov_b32 m0, 106496
s_add_u32 s61, s60, 294912
buffer_load_dwordx4 v12, s[28:31], s60 offen offset:0 nt lds
buffer_load_dwordx4 v13, s[28:31], s60 offen offset:1024 nt lds
buffer_load_dwordx4 v14, s[28:31], s60 offen offset:2048 nt lds
buffer_load_dwordx4 v15, s[28:31], s60 offen offset:3072 nt lds
s_mov_b32 m0, 110592
s_nop 0
buffer_load_dwordx4 v12, s[28:31], s61 offen offset:0 nt lds
buffer_load_dwordx4 v13, s[28:31], s61 offen offset:1024 nt lds
buffer_load_dwordx4 v14, s[28:31], s61 offen offset:2048 nt lds
buffer_load_dwordx4 v15, s[28:31], s61 offen offset:3072 nt lds
s_waitcnt vmcnt(16)
s_barrier
s_add_u32 s60, s54, 256
s_mov_b32 m0, 131072
s_add_u32 s61, s60, 294912
buffer_load_dwordx4 v12, s[28:31], s60 offen offset:0 nt lds
buffer_load_dwordx4 v13, s[28:31], s60 offen offset:1024 nt lds
buffer_load_dwordx4 v14, s[28:31], s60 offen offset:2048 nt lds
buffer_load_dwordx4 v15, s[28:31], s60 offen offset:3072 nt lds
s_mov_b32 m0, 135168
s_nop 0
buffer_load_dwordx4 v12, s[28:31], s61 offen offset:0 nt lds
buffer_load_dwordx4 v13, s[28:31], s61 offen offset:1024 nt lds
buffer_load_dwordx4 v14, s[28:31], s61 offen offset:2048 nt lds
buffer_load_dwordx4 v15, s[28:31], s61 offen offset:3072 nt lds
s_waitcnt vmcnt(16)
s_barrier
s_add_u32 s60, s55, 256
s_mov_b32 m0, 155648
s_add_u32 s61, s60, 294912
buffer_load_dwordx4 v12, s[28:31], s60 offen offset:0 nt lds
buffer_load_dwordx4 v13, s[28:31], s60 offen offset:1024 nt lds
buffer_load_dwordx4 v14, s[28:31], s60 offen offset:2048 nt lds
buffer_load_dwordx4 v15, s[28:31], s60 offen offset:3072 nt lds
s_mov_b32 m0, 159744
s_nop 0
buffer_load_dwordx4 v12, s[28:31], s61 offen offset:0 nt lds
buffer_load_dwordx4 v13, s[28:31], s61 offen offset:1024 nt lds
buffer_load_dwordx4 v14, s[28:31], s61 offen offset:2048 nt lds
buffer_load_dwordx4 v15, s[28:31], s61 offen offset:3072 nt lds
s_waitcnt vmcnt(16)
s_barrier
s_add_u32 s60, s56, 256
s_mov_b32 m0, 90112
s_add_u32 s61, s60, 294912
buffer_load_dwordx4 v12, s[28:31], s60 offen offset:0 nt lds
buffer_load_dwordx4 v13, s[28:31], s60 offen offset:1024 nt lds
buffer_load_dwordx4 v14, s[28:31], s60 offen offset:2048 nt lds
buffer_load_dwordx4 v15, s[28:31], s60 offen offset:3072 nt lds
s_mov_b32 m0, 94208
s_nop 0
buffer_load_dwordx4 v12, s[28:31], s61 offen offset:0 nt lds
buffer_load_dwordx4 v13, s[28:31], s61 offen offset:1024 nt lds
buffer_load_dwordx4 v14, s[28:31], s61 offen offset:2048 nt lds
buffer_load_dwordx4 v15, s[28:31], s61 offen offset:3072 nt lds
s_waitcnt vmcnt(16)
s_barrier
s_add_u32 s60, s57, 0
s_mov_b32 m0, 114688
s_add_u32 s61, s60, 36864
buffer_load_dwordx4 v16, s[32:35], s60 offen offset:0 nt lds
buffer_load_dwordx4 v17, s[32:35], s60 offen offset:1024 nt lds
buffer_load_dwordx4 v18, s[32:35], s60 offen offset:2048 nt lds
buffer_load_dwordx4 v19, s[32:35], s60 offen offset:3072 nt lds
s_mov_b32 m0, 118784
s_nop 0
buffer_load_dwordx4 v16, s[32:35], s61 offen offset:0 nt lds
buffer_load_dwordx4 v17, s[32:35], s61 offen offset:1024 nt lds
buffer_load_dwordx4 v18, s[32:35], s61 offen offset:2048 nt lds
buffer_load_dwordx4 v19, s[32:35], s61 offen offset:3072 nt lds
s_waitcnt vmcnt(16)
s_barrier
s_add_u32 s60, s57, 128
s_mov_b32 m0, 139264
s_add_u32 s61, s60, 36864
buffer_load_dwordx4 v16, s[32:35], s60 offen offset:0 nt lds
buffer_load_dwordx4 v17, s[32:35], s60 offen offset:1024 nt lds
buffer_load_dwordx4 v18, s[32:35], s60 offen offset:2048 nt lds
buffer_load_dwordx4 v19, s[32:35], s60 offen offset:3072 nt lds
s_mov_b32 m0, 143360
s_nop 0
buffer_load_dwordx4 v16, s[32:35], s61 offen offset:0 nt lds
buffer_load_dwordx4 v17, s[32:35], s61 offen offset:1024 nt lds
buffer_load_dwordx4 v18, s[32:35], s61 offen offset:2048 nt lds
buffer_load_dwordx4 v19, s[32:35], s61 offen offset:3072 nt lds
s_waitcnt vmcnt(16)
s_barrier
s_add_u32 s60, s47, 0
s_mov_b32 m0, 0
s_add_u32 s61, s60, 4096
buffer_load_dwordx4 v20, s[36:39], s60 offen offset:0 sc1 lds
buffer_load_dwordx4 v20, s[36:39], s60 offen offset:1024 sc1 lds
buffer_load_dwordx4 v20, s[36:39], s60 offen offset:2048 sc1 lds
buffer_load_dwordx4 v20, s[36:39], s60 offen offset:3072 sc1 lds
s_mov_b32 m0, 4096
s_nop 0
buffer_load_dwordx4 v20, s[36:39], s61 offen offset:0 sc1 lds
buffer_load_dwordx4 v20, s[36:39], s61 offen offset:1024 sc1 lds
buffer_load_dwordx4 v20, s[36:39], s61 offen offset:2048 sc1 lds
buffer_load_dwordx4 v20, s[36:39], s61 offen offset:3072 sc1 lds
s_add_u32 s60, s57, 256
s_mov_b32 m0, 73728
s_add_u32 s61, s60, 36864
buffer_load_dwordx4 v16, s[32:35], s60 offen offset:0 nt lds
buffer_load_dwordx4 v17, s[32:35], s60 offen offset:1024 nt lds
buffer_load_dwordx4 v18, s[32:35], s60 offen offset:2048 nt lds
buffer_load_dwordx4 v19, s[32:35], s60 offen offset:3072 nt lds
s_mov_b32 m0, 77824
s_nop 0
buffer_load_dwordx4 v16, s[32:35], s61 offen offset:0 nt lds
buffer_load_dwordx4 v17, s[32:35], s61 offen offset:1024 nt lds
buffer_load_dwordx4 v18, s[32:35], s61 offen offset:2048 nt lds
buffer_load_dwordx4 v19, s[32:35], s61 offen offset:3072 nt lds
s_waitcnt vmcnt(8)
s_barrier
s_add_u32 s60, s57, 73728
s_mov_b32 m0, 98304
s_add_u32 s61, s60, 36864
buffer_load_dwordx4 v16, s[32:35], s60 offen offset:0 nt lds
buffer_load_dwordx4 v17, s[32:35], s60 offen offset:1024 nt lds
buffer_load_dwordx4 v18, s[32:35], s60 offen offset:2048 nt lds
buffer_load_dwordx4 v19, s[32:35], s60 offen offset:3072 nt lds
s_mov_b32 m0, 102400
s_nop 0
buffer_load_dwordx4 v16, s[32:35], s61 offen offset:0 nt lds
buffer_load_dwordx4 v17, s[32:35], s61 offen offset:1024 nt lds
buffer_load_dwordx4 v18, s[32:35], s61 offen offset:2048 nt lds
buffer_load_dwordx4 v19, s[32:35], s61 offen offset:3072 nt lds
s_waitcnt vmcnt(24)
s_barrier
s_add_u32 s60, s57, 73856
s_mov_b32 m0, 122880
s_add_u32 s61, s60, 36864
buffer_load_dwordx4 v16, s[32:35], s60 offen offset:0 nt lds
buffer_load_dwordx4 v17, s[32:35], s60 offen offset:1024 nt lds
buffer_load_dwordx4 v18, s[32:35], s60 offen offset:2048 nt lds
buffer_load_dwordx4 v19, s[32:35], s60 offen offset:3072 nt lds
s_mov_b32 m0, 126976
s_nop 0
buffer_load_dwordx4 v16, s[32:35], s61 offen offset:0 nt lds
buffer_load_dwordx4 v17, s[32:35], s61 offen offset:1024 nt lds
buffer_load_dwordx4 v18, s[32:35], s61 offen offset:2048 nt lds
buffer_load_dwordx4 v19, s[32:35], s61 offen offset:3072 nt lds
s_waitcnt vmcnt(16)
s_barrier
s_add_u32 s60, s47, 8192
s_mov_b32 m0, 24576
s_add_u32 s61, s60, 4096
buffer_load_dwordx4 v20, s[36:39], s60 offen offset:0 sc1 lds
buffer_load_dwordx4 v20, s[36:39], s60 offen offset:1024 sc1 lds
buffer_load_dwordx4 v20, s[36:39], s60 offen offset:2048 sc1 lds
buffer_load_dwordx4 v20, s[36:39], s60 offen offset:3072 sc1 lds
s_mov_b32 m0, 28672
s_nop 0
buffer_load_dwordx4 v20, s[36:39], s61 offen offset:0 sc1 lds
buffer_load_dwordx4 v20, s[36:39], s61 offen offset:1024 sc1 lds
buffer_load_dwordx4 v20, s[36:39], s61 offen offset:2048 sc1 lds
buffer_load_dwordx4 v20, s[36:39], s61 offen offset:3072 sc1 lds
s_add_u32 s60, s57, 147456
s_mov_b32 m0, 147456
s_add_u32 s61, s60, 36864
buffer_load_dwordx4 v16, s[32:35], s60 offen offset:0 nt lds
buffer_load_dwordx4 v17, s[32:35], s60 offen offset:1024 nt lds
buffer_load_dwordx4 v18, s[32:35], s60 offen offset:2048 nt lds
buffer_load_dwordx4 v19, s[32:35], s60 offen offset:3072 nt lds
s_mov_b32 m0, 151552
s_nop 0
buffer_load_dwordx4 v16, s[32:35], s61 offen offset:0 nt lds
buffer_load_dwordx4 v17, s[32:35], s61 offen offset:1024 nt lds
buffer_load_dwordx4 v18, s[32:35], s61 offen offset:2048 nt lds
buffer_load_dwordx4 v19, s[32:35], s61 offen offset:3072 nt lds
s_waitcnt vmcnt(8)
s_barrier
s_add_u32 s60, s57, 147584
s_mov_b32 m0, 81920
s_add_u32 s61, s60, 36864
buffer_load_dwordx4 v16, s[32:35], s60 offen offset:0 nt lds
buffer_load_dwordx4 v17, s[32:35], s60 offen offset:1024 nt lds
buffer_load_dwordx4 v18, s[32:35], s60 offen offset:2048 nt lds
buffer_load_dwordx4 v19, s[32:35], s60 offen offset:3072 nt lds
s_mov_b32 m0, 86016
s_nop 0
buffer_load_dwordx4 v16, s[32:35], s61 offen offset:0 nt lds
buffer_load_dwordx4 v17, s[32:35], s61 offen offset:1024 nt lds
buffer_load_dwordx4 v18, s[32:35], s61 offen offset:2048 nt lds
buffer_load_dwordx4 v19, s[32:35], s61 offen offset:3072 nt lds
s_waitcnt vmcnt(24)
s_barrier
s_add_u32 s60, s47, 16384
s_mov_b32 m0, 49152
s_add_u32 s61, s60, 4096
buffer_load_dwordx4 v20, s[36:39], s60 offen offset:0 sc1 lds
buffer_load_dwordx4 v20, s[36:39], s60 offen offset:1024 sc1 lds
buffer_load_dwordx4 v20, s[36:39], s60 offen offset:2048 sc1 lds
buffer_load_dwordx4 v20, s[36:39], s60 offen offset:3072 sc1 lds
s_mov_b32 m0, 53248
s_nop 0
buffer_load_dwordx4 v20, s[36:39], s61 offen offset:0 sc1 lds
buffer_load_dwordx4 v20, s[36:39], s61 offen offset:1024 sc1 lds
buffer_load_dwordx4 v20, s[36:39], s61 offen offset:2048 sc1 lds
buffer_load_dwordx4 v20, s[36:39], s61 offen offset:3072 sc1 lds
s_add_u32 s60, s57, 73984
s_mov_b32 m0, 106496
s_add_u32 s61, s60, 36864
buffer_load_dwordx4 v16, s[32:35], s60 offen offset:0 nt lds
buffer_load_dwordx4 v17, s[32:35], s60 offen offset:1024 nt lds
buffer_load_dwordx4 v18, s[32:35], s60 offen offset:2048 nt lds
buffer_load_dwordx4 v19, s[32:35], s60 offen offset:3072 nt lds
s_mov_b32 m0, 110592
s_nop 0
buffer_load_dwordx4 v16, s[32:35], s61 offen offset:0 nt lds
buffer_load_dwordx4 v17, s[32:35], s61 offen offset:1024 nt lds
buffer_load_dwordx4 v18, s[32:35], s61 offen offset:2048 nt lds
buffer_load_dwordx4 v19, s[32:35], s61 offen offset:3072 nt lds
s_waitcnt vmcnt(8)
s_barrier
s_add_u32 s60, s57, 147712
s_mov_b32 m0, 131072
s_add_u32 s61, s60, 36864
buffer_load_dwordx4 v16, s[32:35], s60 offen offset:0 nt lds
buffer_load_dwordx4 v17, s[32:35], s60 offen offset:1024 nt lds
buffer_load_dwordx4 v18, s[32:35], s60 offen offset:2048 nt lds
buffer_load_dwordx4 v19, s[32:35], s60 offen offset:3072 nt lds
s_mov_b32 m0, 135168
s_nop 0
buffer_load_dwordx4 v16, s[32:35], s61 offen offset:0 nt lds
buffer_load_dwordx4 v17, s[32:35], s61 offen offset:1024 nt lds
buffer_load_dwordx4 v18, s[32:35], s61 offen offset:2048 nt lds
buffer_load_dwordx4 v19, s[32:35], s61 offen offset:3072 nt lds
s_waitcnt vmcnt(24)
s_barrier
s_waitcnt vmcnt(8)
s_barrier
s_waitcnt vmcnt(0)
s_barrier
s_branch L_gather
L_loader1:
s_waitcnt vmcnt(16)
s_barrier
s_mov_b32 m0, 57344
s_add_u32 s61, s53, 36864
buffer_load_dwordx4 v8, s[24:27], s53 offen offset:0  lds
buffer_load_dwordx4 v9, s[24:27], s53 offen offset:1024  lds
buffer_load_dwordx4 v10, s[24:27], s53 offen offset:2048  lds
buffer_load_dwordx4 v11, s[24:27], s53 offen offset:3072  lds
s_mov_b32 m0, 61440
s_nop 0
buffer_load_dwordx4 v8, s[24:27], s61 offen offset:0  lds
buffer_load_dwordx4 v9, s[24:27], s61 offen offset:1024  lds
buffer_load_dwordx4 v10, s[24:27], s61 offen offset:2048  lds
buffer_load_dwordx4 v11, s[24:27], s61 offen offset:3072  lds
s_add_u32 s60, s56, 0
s_mov_b32 m0, 131072
s_add_u32 s61, s60, 294912
buffer_load_dwordx4 v12, s[28:31], s60 offen offset:0 nt lds
buffer_load_dwordx4 v13, s[28:31], s60 offen offset:1024 nt lds
buffer_load_dwordx4 v14, s[28:31], s60 offen offset:2048 nt lds
buffer_load_dwordx4 v15, s[28:31], s60 offen offset:3072 nt lds
s_mov_b32 m0, 135168
s_nop 0
buffer_load_dwordx4 v12, s[28:31], s61 offen offset:0 nt lds
buffer_load_dwordx4 v13, s[28:31], s61 offen offset:1024 nt lds
buffer_load_dwordx4 v14, s[28:31], s61 offen offset:2048 nt lds
buffer_load_dwordx4 v15, s[28:31], s61 offen offset:3072 nt lds
s_waitcnt vmcnt(16)
s_barrier
s_add_u32 s60, s54, 128
s_mov_b32 m0, 155648
s_add_u32 s61, s60, 294912
buffer_load_dwordx4 v12, s[28:31], s60 offen offset:0 nt lds
buffer_load_dwordx4 v13, s[28:31], s60 offen offset:1024 nt lds
buffer_load_dwordx4 v14, s[28:31], s60 offen offset:2048 nt lds
buffer_load_dwordx4 v15, s[28:31], s60 offen offset:3072 nt lds
s_mov_b32 m0, 159744
s_nop 0
buffer_load_dwordx4 v12, s[28:31], s61 offen offset:0 nt lds
buffer_load_dwordx4 v13, s[28:31], s61 offen offset:1024 nt lds
buffer_load_dwordx4 v14, s[28:31], s61 offen offset:2048 nt lds
buffer_load_dwordx4 v15, s[28:31], s61 offen offset:3072 nt lds
s_add_u32 s60, s55, 128
s_mov_b32 m0, 90112
s_add_u32 s61, s60, 294912
buffer_load_dwordx4 v12, s[28:31], s60 offen offset:0 nt lds
buffer_load_dwordx4 v13, s[28:31], s60 offen offset:1024 nt lds
buffer_load_dwordx4 v14, s[28:31], s60 offen offset:2048 nt lds
buffer_load_dwordx4 v15, s[28:31], s60 offen offset:3072 nt lds
s_mov_b32 m0, 94208
s_nop 0
buffer_load_dwordx4 v12, s[28:31], s61 offen offset:0 nt lds
buffer_load_dwordx4 v13, s[28:31], s61 offen offset:1024 nt lds
buffer_load_dwordx4 v14, s[28:31], s61 offen offset:2048 nt lds
buffer_load_dwordx4 v15, s[28:31], s61 offen offset:3072 nt lds
s_waitcnt vmcnt(16)
s_barrier
s_add_u32 s60, s56, 128
s_mov_b32 m0, 114688
s_add_u32 s61, s60, 294912
buffer_load_dwordx4 v12, s[28:31], s60 offen offset:0 nt lds
buffer_load_dwordx4 v13, s[28:31], s60 offen offset:1024 nt lds
buffer_load_dwordx4 v14, s[28:31], s60 offen offset:2048 nt lds
buffer_load_dwordx4 v15, s[28:31], s60 offen offset:3072 nt lds
s_mov_b32 m0, 118784
s_nop 0
buffer_load_dwordx4 v12, s[28:31], s61 offen offset:0 nt lds
buffer_load_dwordx4 v13, s[28:31], s61 offen offset:1024 nt lds
buffer_load_dwordx4 v14, s[28:31], s61 offen offset:2048 nt lds
buffer_load_dwordx4 v15, s[28:31], s61 offen offset:3072 nt lds
s_waitcnt vmcnt(16)
s_barrier
s_add_u32 s60, s54, 256
s_mov_b32 m0, 139264
s_add_u32 s61, s60, 294912
buffer_load_dwordx4 v12, s[28:31], s60 offen offset:0 nt lds
buffer_load_dwordx4 v13, s[28:31], s60 offen offset:1024 nt lds
buffer_load_dwordx4 v14, s[28:31], s60 offen offset:2048 nt lds
buffer_load_dwordx4 v15, s[28:31], s60 offen offset:3072 nt lds
s_mov_b32 m0, 143360
s_nop 0
buffer_load_dwordx4 v12, s[28:31], s61 offen offset:0 nt lds
buffer_load_dwordx4 v13, s[28:31], s61 offen offset:1024 nt lds
buffer_load_dwordx4 v14, s[28:31], s61 offen offset:2048 nt lds
buffer_load_dwordx4 v15, s[28:31], s61 offen offset:3072 nt lds
s_waitcnt vmcnt(16)
s_barrier
s_add_u32 s60, s55, 256
s_mov_b32 m0, 73728
s_add_u32 s61, s60, 294912
buffer_load_dwordx4 v12, s[28:31], s60 offen offset:0 nt lds
buffer_load_dwordx4 v13, s[28:31], s60 offen offset:1024 nt lds
buffer_load_dwordx4 v14, s[28:31], s60 offen offset:2048 nt lds
buffer_load_dwordx4 v15, s[28:31], s60 offen offset:3072 nt lds
s_mov_b32 m0, 77824
s_nop 0
buffer_load_dwordx4 v12, s[28:31], s61 offen offset:0 nt lds
buffer_load_dwordx4 v13, s[28:31], s61 offen offset:1024 nt lds
buffer_load_dwordx4 v14, s[28:31], s61 offen offset:2048 nt lds
buffer_load_dwordx4 v15, s[28:31], s61 offen offset:3072 nt lds
s_waitcnt vmcnt(16)
s_barrier
s_add_u32 s60, s56, 256
s_mov_b32 m0, 98304
s_add_u32 s61, s60, 294912
buffer_load_dwordx4 v12, s[28:31], s60 offen offset:0 nt lds
buffer_load_dwordx4 v13, s[28:31], s60 offen offset:1024 nt lds
buffer_load_dwordx4 v14, s[28:31], s60 offen offset:2048 nt lds
buffer_load_dwordx4 v15, s[28:31], s60 offen offset:3072 nt lds
s_mov_b32 m0, 102400
s_nop 0
buffer_load_dwordx4 v12, s[28:31], s61 offen offset:0 nt lds
buffer_load_dwordx4 v13, s[28:31], s61 offen offset:1024 nt lds
buffer_load_dwordx4 v14, s[28:31], s61 offen offset:2048 nt lds
buffer_load_dwordx4 v15, s[28:31], s61 offen offset:3072 nt lds
s_waitcnt vmcnt(16)
s_barrier
s_add_u32 s60, s58, 0
s_mov_b32 m0, 122880
s_add_u32 s61, s60, 36864
buffer_load_dwordx4 v16, s[32:35], s60 offen offset:0 nt lds
buffer_load_dwordx4 v17, s[32:35], s60 offen offset:1024 nt lds
buffer_load_dwordx4 v18, s[32:35], s60 offen offset:2048 nt lds
buffer_load_dwordx4 v19, s[32:35], s60 offen offset:3072 nt lds
s_mov_b32 m0, 126976
s_nop 0
buffer_load_dwordx4 v16, s[32:35], s61 offen offset:0 nt lds
buffer_load_dwordx4 v17, s[32:35], s61 offen offset:1024 nt lds
buffer_load_dwordx4 v18, s[32:35], s61 offen offset:2048 nt lds
buffer_load_dwordx4 v19, s[32:35], s61 offen offset:3072 nt lds
s_waitcnt vmcnt(16)
s_barrier
s_add_u32 s60, s58, 128
s_mov_b32 m0, 147456
s_add_u32 s61, s60, 36864
buffer_load_dwordx4 v16, s[32:35], s60 offen offset:0 nt lds
buffer_load_dwordx4 v17, s[32:35], s60 offen offset:1024 nt lds
buffer_load_dwordx4 v18, s[32:35], s60 offen offset:2048 nt lds
buffer_load_dwordx4 v19, s[32:35], s60 offen offset:3072 nt lds
s_mov_b32 m0, 151552
s_nop 0
buffer_load_dwordx4 v16, s[32:35], s61 offen offset:0 nt lds
buffer_load_dwordx4 v17, s[32:35], s61 offen offset:1024 nt lds
buffer_load_dwordx4 v18, s[32:35], s61 offen offset:2048 nt lds
buffer_load_dwordx4 v19, s[32:35], s61 offen offset:3072 nt lds
s_waitcnt vmcnt(16)
s_barrier
s_add_u32 s60, s47, 0
s_mov_b32 m0, 8192
s_add_u32 s61, s60, 4096
buffer_load_dwordx4 v20, s[36:39], s60 offen offset:0 sc1 lds
buffer_load_dwordx4 v20, s[36:39], s60 offen offset:1024 sc1 lds
buffer_load_dwordx4 v20, s[36:39], s60 offen offset:2048 sc1 lds
buffer_load_dwordx4 v20, s[36:39], s60 offen offset:3072 sc1 lds
s_mov_b32 m0, 12288
s_nop 0
buffer_load_dwordx4 v20, s[36:39], s61 offen offset:0 sc1 lds
buffer_load_dwordx4 v20, s[36:39], s61 offen offset:1024 sc1 lds
buffer_load_dwordx4 v20, s[36:39], s61 offen offset:2048 sc1 lds
buffer_load_dwordx4 v20, s[36:39], s61 offen offset:3072 sc1 lds
s_add_u32 s60, s58, 256
s_mov_b32 m0, 81920
s_add_u32 s61, s60, 36864
buffer_load_dwordx4 v16, s[32:35], s60 offen offset:0 nt lds
buffer_load_dwordx4 v17, s[32:35], s60 offen offset:1024 nt lds
buffer_load_dwordx4 v18, s[32:35], s60 offen offset:2048 nt lds
buffer_load_dwordx4 v19, s[32:35], s60 offen offset:3072 nt lds
s_mov_b32 m0, 86016
s_nop 0
buffer_load_dwordx4 v16, s[32:35], s61 offen offset:0 nt lds
buffer_load_dwordx4 v17, s[32:35], s61 offen offset:1024 nt lds
buffer_load_dwordx4 v18, s[32:35], s61 offen offset:2048 nt lds
buffer_load_dwordx4 v19, s[32:35], s61 offen offset:3072 nt lds
s_waitcnt vmcnt(8)
s_barrier
s_add_u32 s60, s58, 73728
s_mov_b32 m0, 106496
s_add_u32 s61, s60, 36864
buffer_load_dwordx4 v16, s[32:35], s60 offen offset:0 nt lds
buffer_load_dwordx4 v17, s[32:35], s60 offen offset:1024 nt lds
buffer_load_dwordx4 v18, s[32:35], s60 offen offset:2048 nt lds
buffer_load_dwordx4 v19, s[32:35], s60 offen offset:3072 nt lds
s_mov_b32 m0, 110592
s_nop 0
buffer_load_dwordx4 v16, s[32:35], s61 offen offset:0 nt lds
buffer_load_dwordx4 v17, s[32:35], s61 offen offset:1024 nt lds
buffer_load_dwordx4 v18, s[32:35], s61 offen offset:2048 nt lds
buffer_load_dwordx4 v19, s[32:35], s61 offen offset:3072 nt lds
s_waitcnt vmcnt(24)
s_barrier
s_add_u32 s60, s58, 73856
s_mov_b32 m0, 131072
s_add_u32 s61, s60, 36864
buffer_load_dwordx4 v16, s[32:35], s60 offen offset:0 nt lds
buffer_load_dwordx4 v17, s[32:35], s60 offen offset:1024 nt lds
buffer_load_dwordx4 v18, s[32:35], s60 offen offset:2048 nt lds
buffer_load_dwordx4 v19, s[32:35], s60 offen offset:3072 nt lds
s_mov_b32 m0, 135168
s_nop 0
buffer_load_dwordx4 v16, s[32:35], s61 offen offset:0 nt lds
buffer_load_dwordx4 v17, s[32:35], s61 offen offset:1024 nt lds
buffer_load_dwordx4 v18, s[32:35], s61 offen offset:2048 nt lds
buffer_load_dwordx4 v19, s[32:35], s61 offen offset:3072 nt lds
s_waitcnt vmcnt(16)
s_barrier
s_add_u32 s60, s47, 8192
s_mov_b32 m0, 32768
s_add_u32 s61, s60, 4096
buffer_load_dwordx4 v20, s[36:39], s60 offen offset:0 sc1 lds
buffer_load_dwordx4 v20, s[36:39], s60 offen offset:1024 sc1 lds
buffer_load_dwordx4 v20, s[36:39], s60 offen offset:2048 sc1 lds
buffer_load_dwordx4 v20, s[36:39], s60 offen offset:3072 sc1 lds
s_mov_b32 m0, 36864
s_nop 0
buffer_load_dwordx4 v20, s[36:39], s61 offen offset:0 sc1 lds
buffer_load_dwordx4 v20, s[36:39], s61 offen offset:1024 sc1 lds
buffer_load_dwordx4 v20, s[36:39], s61 offen offset:2048 sc1 lds
buffer_load_dwordx4 v20, s[36:39], s61 offen offset:3072 sc1 lds
s_add_u32 s60, s58, 147456
s_mov_b32 m0, 155648
s_add_u32 s61, s60, 36864
buffer_load_dwordx4 v16, s[32:35], s60 offen offset:0 nt lds
buffer_load_dwordx4 v17, s[32:35], s60 offen offset:1024 nt lds
buffer_load_dwordx4 v18, s[32:35], s60 offen offset:2048 nt lds
buffer_load_dwordx4 v19, s[32:35], s60 offen offset:3072 nt lds
s_mov_b32 m0, 159744
s_nop 0
buffer_load_dwordx4 v16, s[32:35], s61 offen offset:0 nt lds
buffer_load_dwordx4 v17, s[32:35], s61 offen offset:1024 nt lds
buffer_load_dwordx4 v18, s[32:35], s61 offen offset:2048 nt lds
buffer_load_dwordx4 v19, s[32:35], s61 offen offset:3072 nt lds
s_waitcnt vmcnt(8)
s_barrier
s_add_u32 s60, s58, 147584
s_mov_b32 m0, 90112
s_add_u32 s61, s60, 36864
buffer_load_dwordx4 v16, s[32:35], s60 offen offset:0 nt lds
buffer_load_dwordx4 v17, s[32:35], s60 offen offset:1024 nt lds
buffer_load_dwordx4 v18, s[32:35], s60 offen offset:2048 nt lds
buffer_load_dwordx4 v19, s[32:35], s60 offen offset:3072 nt lds
s_mov_b32 m0, 94208
s_nop 0
buffer_load_dwordx4 v16, s[32:35], s61 offen offset:0 nt lds
buffer_load_dwordx4 v17, s[32:35], s61 offen offset:1024 nt lds
buffer_load_dwordx4 v18, s[32:35], s61 offen offset:2048 nt lds
buffer_load_dwordx4 v19, s[32:35], s61 offen offset:3072 nt lds
s_waitcnt vmcnt(24)
s_barrier
s_add_u32 s60, s47, 16384
s_mov_b32 m0, 57344
s_add_u32 s61, s60, 4096
buffer_load_dwordx4 v20, s[36:39], s60 offen offset:0 sc1 lds
buffer_load_dwordx4 v20, s[36:39], s60 offen offset:1024 sc1 lds
buffer_load_dwordx4 v20, s[36:39], s60 offen offset:2048 sc1 lds
buffer_load_dwordx4 v20, s[36:39], s60 offen offset:3072 sc1 lds
s_mov_b32 m0, 61440
s_nop 0
buffer_load_dwordx4 v20, s[36:39], s61 offen offset:0 sc1 lds
buffer_load_dwordx4 v20, s[36:39], s61 offen offset:1024 sc1 lds
buffer_load_dwordx4 v20, s[36:39], s61 offen offset:2048 sc1 lds
buffer_load_dwordx4 v20, s[36:39], s61 offen offset:3072 sc1 lds
s_add_u32 s60, s58, 73984
s_mov_b32 m0, 114688
s_add_u32 s61, s60, 36864
buffer_load_dwordx4 v16, s[32:35], s60 offen offset:0 nt lds
buffer_load_dwordx4 v17, s[32:35], s60 offen offset:1024 nt lds
buffer_load_dwordx4 v18, s[32:35], s60 offen offset:2048 nt lds
buffer_load_dwordx4 v19, s[32:35], s60 offen offset:3072 nt lds
s_mov_b32 m0, 118784
s_nop 0
buffer_load_dwordx4 v16, s[32:35], s61 offen offset:0 nt lds
buffer_load_dwordx4 v17, s[32:35], s61 offen offset:1024 nt lds
buffer_load_dwordx4 v18, s[32:35], s61 offen offset:2048 nt lds
buffer_load_dwordx4 v19, s[32:35], s61 offen offset:3072 nt lds
s_waitcnt vmcnt(8)
s_barrier
s_add_u32 s60, s58, 147712
s_mov_b32 m0, 139264
s_add_u32 s61, s60, 36864
buffer_load_dwordx4 v16, s[32:35], s60 offen offset:0 nt lds
buffer_load_dwordx4 v17, s[32:35], s60 offen offset:1024 nt lds
buffer_load_dwordx4 v18, s[32:35], s60 offen offset:2048 nt lds
buffer_load_dwordx4 v19, s[32:35], s60 offen offset:3072 nt lds
s_mov_b32 m0, 143360
s_nop 0
buffer_load_dwordx4 v16, s[32:35], s61 offen offset:0 nt lds
buffer_load_dwordx4 v17, s[32:35], s61 offen offset:1024 nt lds
buffer_load_dwordx4 v18, s[32:35], s61 offen offset:2048 nt lds
buffer_load_dwordx4 v19, s[32:35], s61 offen offset:3072 nt lds
s_waitcnt vmcnt(24)
s_barrier
s_waitcnt vmcnt(8)
s_barrier
s_waitcnt vmcnt(0)
s_barrier
s_branch L_gather
L_loader2:
s_waitcnt vmcnt(16)
s_barrier
s_mov_b32 m0, 65536
s_add_u32 s61, s53, 36864
buffer_load_dwordx4 v8, s[24:27], s53 offen offset:0  lds
buffer_load_dwordx4 v9, s[24:27], s53 offen offset:1024  lds
buffer_load_dwordx4 v10, s[24:27], s53 offen offset:2048  lds
buffer_load_dwordx4 v11, s[24:27], s53 offen offset:3072  lds
s_mov_b32 m0, 69632
s_nop 0
buffer_load_dwordx4 v8, s[24:27], s61 offen offset:0  lds
buffer_load_dwordx4 v9, s[24:27], s61 offen offset:1024  lds
buffer_load_dwordx4 v10, s[24:27], s61 offen offset:2048  lds
buffer_load_dwordx4 v11, s[24:27], s61 offen offset:3072  lds
s_add_u32 s60, s56, 0
s_mov_b32 m0, 139264
s_add_u32 s61, s60, 294912
buffer_load_dwordx4 v12, s[28:31], s60 offen offset:0 nt lds
buffer_load_dwordx4 v13, s[28:31], s60 offen offset:1024 nt lds
buffer_load_dwordx4 v14, s[28:31], s60 offen offset:2048 nt lds
buffer_load_dwordx4 v15, s[28:31], s60 offen offset:3072 nt lds
s_mov_b32 m0, 143360
s_nop 0
buffer_load_dwordx4 v12, s[28:31], s61 offen offset:0 nt lds
buffer_load_dwordx4 v13, s[28:31], s61 offen offset:1024 nt lds
buffer_load_dwordx4 v14, s[28:31], s61 offen offset:2048 nt lds
buffer_load_dwordx4 v15, s[28:31], s61 offen offset:3072 nt lds
s_waitcnt vmcnt(16)
s_barrier
s_add_u32 s60, s54, 128
s_mov_b32 m0, 73728
s_add_u32 s61, s60, 294912
buffer_load_dwordx4 v12, s[28:31], s60 offen offset:0 nt lds
buffer_load_dwordx4 v13, s[28:31], s60 offen offset:1024 nt lds
buffer_load_dwordx4 v14, s[28:31], s60 offen offset:2048 nt lds
buffer_load_dwordx4 v15, s[28:31], s60 offen offset:3072 nt lds
s_mov_b32 m0, 77824
s_nop 0
buffer_load_dwordx4 v12, s[28:31], s61 offen offset:0 nt lds
buffer_load_dwordx4 v13, s[28:31], s61 offen offset:1024 nt lds
buffer_load_dwordx4 v14, s[28:31], s61 offen offset:2048 nt lds
buffer_load_dwordx4 v15, s[28:31], s61 offen offset:3072 nt lds
s_waitcnt vmcnt(8)
s_barrier
s_add_u32 s60, s55, 128
s_mov_b32 m0, 98304
s_add_u32 s61, s60, 294912
buffer_load_dwordx4 v12, s[28:31], s60 offen offset:0 nt lds
buffer_load_dwordx4 v13, s[28:31], s60 offen offset:1024 nt lds
buffer_load_dwordx4 v14, s[28:31], s60 offen offset:2048 nt lds
buffer_load_dwordx4 v15, s[28:31], s60 offen offset:3072 nt lds
s_mov_b32 m0, 102400
s_nop 0
buffer_load_dwordx4 v12, s[28:31], s61 offen offset:0 nt lds
buffer_load_dwordx4 v13, s[28:31], s61 offen offset:1024 nt lds
buffer_load_dwordx4 v14, s[28:31], s61 offen offset:2048 nt lds
buffer_load_dwordx4 v15, s[28:31], s61 offen offset:3072 nt lds
s_waitcnt vmcnt(8)
s_barrier
s_add_u32 s60, s56, 128
s_mov_b32 m0, 122880
s_add_u32 s61, s60, 294912
buffer_load_dwordx4 v12, s[28:31], s60 offen offset:0 nt lds
buffer_load_dwordx4 v13, s[28:31], s60 offen offset:1024 nt lds
buffer_load_dwordx4 v14, s[28:31], s60 offen offset:2048 nt lds
buffer_load_dwordx4 v15, s[28:31], s60 offen offset:3072 nt lds
s_mov_b32 m0, 126976
s_nop 0
buffer_load_dwordx4 v12, s[28:31], s61 offen offset:0 nt lds
buffer_load_dwordx4 v13, s[28:31], s61 offen offset:1024 nt lds
buffer_load_dwordx4 v14, s[28:31], s61 offen offset:2048 nt lds
buffer_load_dwordx4 v15, s[28:31], s61 offen offset:3072 nt lds
s_waitcnt vmcnt(8)
s_barrier
s_add_u32 s60, s54, 256
s_mov_b32 m0, 147456
s_add_u32 s61, s60, 294912
buffer_load_dwordx4 v12, s[28:31], s60 offen offset:0 nt lds
buffer_load_dwordx4 v13, s[28:31], s60 offen offset:1024 nt lds
buffer_load_dwordx4 v14, s[28:31], s60 offen offset:2048 nt lds
buffer_load_dwordx4 v15, s[28:31], s60 offen offset:3072 nt lds
s_mov_b32 m0, 151552
s_nop 0
buffer_load_dwordx4 v12, s[28:31], s61 offen offset:0 nt lds
buffer_load_dwordx4 v13, s[28:31], s61 offen offset:1024 nt lds
buffer_load_dwordx4 v14, s[28:31], s61 offen offset:2048 nt lds
buffer_load_dwordx4 v15, s[28:31], s61 offen offset:3072 nt lds
s_waitcnt vmcnt(8)
s_barrier
s_add_u32 s60, s55, 256
s_mov_b32 m0, 81920
s_add_u32 s61, s60, 294912
buffer_load_dwordx4 v12, s[28:31], s60 offen offset:0 nt lds
buffer_load_dwordx4 v13, s[28:31], s60 offen offset:1024 nt lds
buffer_load_dwordx4 v14, s[28:31], s60 offen offset:2048 nt lds
buffer_load_dwordx4 v15, s[28:31], s60 offen offset:3072 nt lds
s_mov_b32 m0, 86016
s_nop 0
buffer_load_dwordx4 v12, s[28:31], s61 offen offset:0 nt lds
buffer_load_dwordx4 v13, s[28:31], s61 offen offset:1024 nt lds
buffer_load_dwordx4 v14, s[28:31], s61 offen offset:2048 nt lds
buffer_load_dwordx4 v15, s[28:31], s61 offen offset:3072 nt lds
s_waitcnt vmcnt(8)
s_barrier
s_add_u32 s60, s56, 256
s_mov_b32 m0, 106496
s_add_u32 s61, s60, 294912
buffer_load_dwordx4 v12, s[28:31], s60 offen offset:0 nt lds
buffer_load_dwordx4 v13, s[28:31], s60 offen offset:1024 nt lds
buffer_load_dwordx4 v14, s[28:31], s60 offen offset:2048 nt lds
buffer_load_dwordx4 v15, s[28:31], s60 offen offset:3072 nt lds
s_mov_b32 m0, 110592
s_nop 0
buffer_load_dwordx4 v12, s[28:31], s61 offen offset:0 nt lds
buffer_load_dwordx4 v13, s[28:31], s61 offen offset:1024 nt lds
buffer_load_dwordx4 v14, s[28:31], s61 offen offset:2048 nt lds
buffer_load_dwordx4 v15, s[28:31], s61 offen offset:3072 nt lds
s_waitcnt vmcnt(8)
s_barrier
s_add_u32 s60, s59, 0
s_mov_b32 m0, 131072
s_add_u32 s61, s60, 36864
buffer_load_dwordx4 v16, s[32:35], s60 offen offset:0 nt lds
buffer_load_dwordx4 v17, s[32:35], s60 offen offset:1024 nt lds
buffer_load_dwordx4 v18, s[32:35], s60 offen offset:2048 nt lds
buffer_load_dwordx4 v19, s[32:35], s60 offen offset:3072 nt lds
s_mov_b32 m0, 135168
s_nop 0
buffer_load_dwordx4 v16, s[32:35], s61 offen offset:0 nt lds
buffer_load_dwordx4 v17, s[32:35], s61 offen offset:1024 nt lds
buffer_load_dwordx4 v18, s[32:35], s61 offen offset:2048 nt lds
buffer_load_dwordx4 v19, s[32:35], s61 offen offset:3072 nt lds
s_waitcnt vmcnt(8)
s_barrier
s_add_u32 s60, s47, 0
s_mov_b32 m0, 16384
s_add_u32 s61, s60, 4096
buffer_load_dwordx4 v20, s[36:39], s60 offen offset:0 sc1 lds
buffer_load_dwordx4 v20, s[36:39], s60 offen offset:1024 sc1 lds
buffer_load_dwordx4 v20, s[36:39], s60 offen offset:2048 sc1 lds
buffer_load_dwordx4 v20, s[36:39], s60 offen offset:3072 sc1 lds
s_mov_b32 m0, 20480
s_nop 0
buffer_load_dwordx4 v20, s[36:39], s61 offen offset:0 sc1 lds
buffer_load_dwordx4 v20, s[36:39], s61 offen offset:1024 sc1 lds
buffer_load_dwordx4 v20, s[36:39], s61 offen offset:2048 sc1 lds
buffer_load_dwordx4 v20, s[36:39], s61 offen offset:3072 sc1 lds
s_add_u32 s60, s59, 128
s_mov_b32 m0, 155648
s_add_u32 s61, s60, 36864
buffer_load_dwordx4 v16, s[32:35], s60 offen offset:0 nt lds
buffer_load_dwordx4 v17, s[32:35], s60 offen offset:1024 nt lds
buffer_load_dwordx4 v18, s[32:35], s60 offen offset:2048 nt lds
buffer_load_dwordx4 v19, s[32:35], s60 offen offset:3072 nt lds
s_mov_b32 m0, 159744
s_nop 0
buffer_load_dwordx4 v16, s[32:35], s61 offen offset:0 nt lds
buffer_load_dwordx4 v17, s[32:35], s61 offen offset:1024 nt lds
buffer_load_dwordx4 v18, s[32:35], s61 offen offset:2048 nt lds
buffer_load_dwordx4 v19, s[32:35], s61 offen offset:3072 nt lds
s_waitcnt vmcnt(8)
s_barrier
s_add_u32 s60, s59, 256
s_mov_b32 m0, 90112
s_add_u32 s61, s60, 36864
buffer_load_dwordx4 v16, s[32:35], s60 offen offset:0 nt lds
buffer_load_dwordx4 v17, s[32:35], s60 offen offset:1024 nt lds
buffer_load_dwordx4 v18, s[32:35], s60 offen offset:2048 nt lds
buffer_load_dwordx4 v19, s[32:35], s60 offen offset:3072 nt lds
s_mov_b32 m0, 94208
s_nop 0
buffer_load_dwordx4 v16, s[32:35], s61 offen offset:0 nt lds
buffer_load_dwordx4 v17, s[32:35], s61 offen offset:1024 nt lds
buffer_load_dwordx4 v18, s[32:35], s61 offen offset:2048 nt lds
buffer_load_dwordx4 v19, s[32:35], s61 offen offset:3072 nt lds
s_waitcnt vmcnt(8)
s_barrier
s_add_u32 s60, s59, 73728
s_mov_b32 m0, 114688
s_add_u32 s61, s60, 36864
buffer_load_dwordx4 v16, s[32:35], s60 offen offset:0 nt lds
buffer_load_dwordx4 v17, s[32:35], s60 offen offset:1024 nt lds
buffer_load_dwordx4 v18, s[32:35], s60 offen offset:2048 nt lds
buffer_load_dwordx4 v19, s[32:35], s60 offen offset:3072 nt lds
s_mov_b32 m0, 118784
s_nop 0
buffer_load_dwordx4 v16, s[32:35], s61 offen offset:0 nt lds
buffer_load_dwordx4 v17, s[32:35], s61 offen offset:1024 nt lds
buffer_load_dwordx4 v18, s[32:35], s61 offen offset:2048 nt lds
buffer_load_dwordx4 v19, s[32:35], s61 offen offset:3072 nt lds
s_waitcnt vmcnt(8)
s_barrier
s_add_u32 s60, s47, 8192
s_mov_b32 m0, 40960
s_add_u32 s61, s60, 4096
buffer_load_dwordx4 v20, s[36:39], s60 offen offset:0 sc1 lds
buffer_load_dwordx4 v20, s[36:39], s60 offen offset:1024 sc1 lds
buffer_load_dwordx4 v20, s[36:39], s60 offen offset:2048 sc1 lds
buffer_load_dwordx4 v20, s[36:39], s60 offen offset:3072 sc1 lds
s_mov_b32 m0, 45056
s_nop 0
buffer_load_dwordx4 v20, s[36:39], s61 offen offset:0 sc1 lds
buffer_load_dwordx4 v20, s[36:39], s61 offen offset:1024 sc1 lds
buffer_load_dwordx4 v20, s[36:39], s61 offen offset:2048 sc1 lds
buffer_load_dwordx4 v20, s[36:39], s61 offen offset:3072 sc1 lds
s_add_u32 s60, s59, 73856
s_mov_b32 m0, 139264
s_add_u32 s61, s60, 36864
buffer_load_dwordx4 v16, s[32:35], s60 offen offset:0 nt lds
buffer_load_dwordx4 v17, s[32:35], s60 offen offset:1024 nt lds
buffer_load_dwordx4 v18, s[32:35], s60 offen offset:2048 nt lds
buffer_load_dwordx4 v19, s[32:35], s60 offen offset:3072 nt lds
s_mov_b32 m0, 143360
s_nop 0
buffer_load_dwordx4 v16, s[32:35], s61 offen offset:0 nt lds
buffer_load_dwordx4 v17, s[32:35], s61 offen offset:1024 nt lds
buffer_load_dwordx4 v18, s[32:35], s61 offen offset:2048 nt lds
buffer_load_dwordx4 v19, s[32:35], s61 offen offset:3072 nt lds
s_waitcnt vmcnt(8)
s_barrier
s_add_u32 s60, s59, 147456
s_mov_b32 m0, 73728
s_add_u32 s61, s60, 36864
buffer_load_dwordx4 v16, s[32:35], s60 offen offset:0 nt lds
buffer_load_dwordx4 v17, s[32:35], s60 offen offset:1024 nt lds
buffer_load_dwordx4 v18, s[32:35], s60 offen offset:2048 nt lds
buffer_load_dwordx4 v19, s[32:35], s60 offen offset:3072 nt lds
s_mov_b32 m0, 77824
s_nop 0
buffer_load_dwordx4 v16, s[32:35], s61 offen offset:0 nt lds
buffer_load_dwordx4 v17, s[32:35], s61 offen offset:1024 nt lds
buffer_load_dwordx4 v18, s[32:35], s61 offen offset:2048 nt lds
buffer_load_dwordx4 v19, s[32:35], s61 offen offset:3072 nt lds
s_waitcnt vmcnt(8)
s_barrier
s_add_u32 s60, s47, 16384
s_mov_b32 m0, 65536
s_add_u32 s61, s60, 4096
buffer_load_dwordx4 v20, s[36:39], s60 offen offset:0 sc1 lds
buffer_load_dwordx4 v20, s[36:39], s60 offen offset:1024 sc1 lds
buffer_load_dwordx4 v20, s[36:39], s60 offen offset:2048 sc1 lds
buffer_load_dwordx4 v20, s[36:39], s60 offen offset:3072 sc1 lds
s_mov_b32 m0, 69632
s_nop 0
buffer_load_dwordx4 v20, s[36:39], s61 offen offset:0 sc1 lds
buffer_load_dwordx4 v20, s[36:39], s61 offen offset:1024 sc1 lds
buffer_load_dwordx4 v20, s[36:39], s61 offen offset:2048 sc1 lds
buffer_load_dwordx4 v20, s[36:39], s61 offen offset:3072 sc1 lds
s_add_u32 s60, s59, 147584
s_mov_b32 m0, 98304
s_add_u32 s61, s60, 36864
buffer_load_dwordx4 v16, s[32:35], s60 offen offset:0 nt lds
buffer_load_dwordx4 v17, s[32:35], s60 offen offset:1024 nt lds
buffer_load_dwordx4 v18, s[32:35], s60 offen offset:2048 nt lds
buffer_load_dwordx4 v19, s[32:35], s60 offen offset:3072 nt lds
s_mov_b32 m0, 102400
s_nop 0
buffer_load_dwordx4 v16, s[32:35], s61 offen offset:0 nt lds
buffer_load_dwordx4 v17, s[32:35], s61 offen offset:1024 nt lds
buffer_load_dwordx4 v18, s[32:35], s61 offen offset:2048 nt lds
buffer_load_dwordx4 v19, s[32:35], s61 offen offset:3072 nt lds
s_waitcnt vmcnt(8)
s_barrier
s_add_u32 s60, s59, 73984
s_mov_b32 m0, 122880
s_add_u32 s61, s60, 36864
buffer_load_dwordx4 v16, s[32:35], s60 offen offset:0 nt lds
buffer_load_dwordx4 v17, s[32:35], s60 offen offset:1024 nt lds
buffer_load_dwordx4 v18, s[32:35], s60 offen offset:2048 nt lds
buffer_load_dwordx4 v19, s[32:35], s60 offen offset:3072 nt lds
s_mov_b32 m0, 126976
s_nop 0
buffer_load_dwordx4 v16, s[32:35], s61 offen offset:0 nt lds
buffer_load_dwordx4 v17, s[32:35], s61 offen offset:1024 nt lds
buffer_load_dwordx4 v18, s[32:35], s61 offen offset:2048 nt lds
buffer_load_dwordx4 v19, s[32:35], s61 offen offset:3072 nt lds
s_waitcnt vmcnt(8)
s_barrier
s_add_u32 s60, s59, 147712
s_mov_b32 m0, 147456
s_add_u32 s61, s60, 36864
buffer_load_dwordx4 v16, s[32:35], s60 offen offset:0 nt lds
buffer_load_dwordx4 v17, s[32:35], s60 offen offset:1024 nt lds
buffer_load_dwordx4 v18, s[32:35], s60 offen offset:2048 nt lds
buffer_load_dwordx4 v19, s[32:35], s60 offen offset:3072 nt lds
s_mov_b32 m0, 151552
s_nop 0
buffer_load_dwordx4 v16, s[32:35], s61 offen offset:0 nt lds
buffer_load_dwordx4 v17, s[32:35], s61 offen offset:1024 nt lds
buffer_load_dwordx4 v18, s[32:35], s61 offen offset:2048 nt lds
buffer_load_dwordx4 v19, s[32:35], s61 offen offset:3072 nt lds
s_waitcnt vmcnt(8)
s_barrier
s_waitcnt vmcnt(0)
s_barrier
s_branch L_gather
L_control:
s_add_u32 s44, s16, 1
s_cmp_eq_u32 s44, 3
s_cselect_b32 s44, 0, s44
s_add_u32 s45, s44, 1
s_cmp_eq_u32 s45, 3
s_cselect_b32 s45, 0, s45
s_lshl_b32 s18, s14, 3
s_add_u32 s18, s18, s15
s_mul_i32 s18, s18, 3
s_add_u32 s18, s18, s16
s_lshl_b32 s3, s15, 7
s_waitcnt lgkmcnt(0)
s_load_dwordx2 s[20:21], s[12:13], s3
s_mov_b32 s36, s12
s_and_b32 s37, s13, 0xffff
s_mov_b32 s38, 268435456
s_mov_b32 s39, 0x20000
s_mov_b32 s40, s10
s_and_b32 s41, s11, 0xffff
s_mov_b32 s42, 589824
s_mov_b32 s43, 0x20000
v_min_u32 v26, 39, v0
v_lshlrev_b32 v26, 18, v26
buffer_load_dword v29, v26, s[36:39], 0 offen offset:2048 sc1
v_min_u32 v27, 8, v0
v_lshlrev_b32 v27, 16, v27
buffer_load_dword v28, v27, s[40:43], 0 offen sc1
s_getreg_b32 s50, hwreg(HW_REG_XCC_ID, 0, 4)
v_lshlrev_b32 v8, 4, v0
s_sub_u32 s22, s18, s16
s_add_u32 s48, s22, s44
s_add_u32 s49, s22, s45
s_lshl_b32 s22, s48, 7
s_lshl_b32 s23, s49, 7
v_mov_b32 v1, s22
v_mov_b32 v2, s23
s_lshl_b32 s60, s18, 7
v_mov_b32 v7, s60
v_lshrrev_b32 v3, 2, v0
v_cmp_eq_u32 vcc, 1, v3
v_and_b32 v6, 3, v0
v_lshlrev_b32 v6, 3, v6
v_cndmask_b32 v4, v7, v1, vcc
v_cmp_eq_u32 vcc, 2, v3
s_mul_i32 s48, s48, 24576
s_mul_i32 s49, s49, 24576
v_cndmask_b32 v4, v4, v2, vcc
v_add_u32 v4, 32768, v4
v_add_u32 v9, v4, v6
v_cmp_eq_u32 vcc, 0, v0
s_mul_i32 s51, s18, 24576
s_add_u32 s51, s51, 262144
v_cndmask_b32 v4, v2, v1, vcc
v_add_u32 v14, 4096, v4
s_add_u32 s48, s48, 262144
s_add_u32 s49, s49, 262144
s_waitcnt lgkmcnt(0)
s_add_u32 s20, s20, 0x7f4a7c15
s_addc_u32 s21, s21, 0x9e3779b9
s_add_u32 s22, s50, 16
s_add_u32 s22, s20, s22
s_addc_u32 s23, s21, 0
v_mov_b32 v4, s22
v_mov_b32 v5, s23
s_lshl_b32 s3, s18, 7
s_add_u32 s3, s3, 4096
v_mov_b32 v6, s3
v_mov_b32 v10, s20
v_mov_b32 v11, s21
s_mov_b64 exec, 1
buffer_store_dwordx2 v[4:5], v6, s[36:39], 0 offen sc1
s_mov_b64 exec, -1
s_barrier
s_barrier
s_mov_b64 exec, 3
buffer_load_dwordx2 v[12:13], v14, s[36:39], 0 offen sc1
s_mov_b64 exec, -1
v_lshlrev_b32 v20, 7, v0
s_mul_i32 s60, s18, 384
s_add_u32 s60, s60, 65536
s_mov_b64 exec, 7
buffer_load_dword v24, v20, s[36:39], s60 offen sc1
s_lshl_b32 s60, s18, 7
s_add_u32 s60, s60, 32768
s_mov_b64 exec, 1
buffer_load_dword v25, v20, s[36:39], s60 offen
s_mov_b64 exec, -1
s_barrier
s_mov_b64 exec, 3
s_mov_b32 s46, 1000000
s_waitcnt vmcnt(2)
s_branch L_check_id
L_poll_id:
buffer_load_dwordx2 v[12:13], v14, s[36:39], 0 offen sc1
s_waitcnt vmcnt(0)
L_check_id:
v_subrev_co_u32 v4, vcc, s20, v12
v_mov_b32 v6, s21
s_nop 0
v_subb_co_u32 v5, vcc, v13, v6, vcc
v_subrev_u32 v4, 16, v4
v_lshrrev_b32 v6, 4, v4
v_or_b32 v6, v6, v5
v_cmp_ne_u32 vcc, 0, v6
s_sub_u32 s46, s46, 1
s_cmp_eq_u32 s46, 0
s_cbranch_scc1 L_id_done
s_nop 1
s_cbranch_vccz L_id_done
s_sleep 1
s_branch L_poll_id
L_id_done:
v_cmp_ne_u32 vcc, s50, v4
s_mov_b32 s19, 1
s_nop 1
s_cmp_eq_u64 vcc, 0
s_cselect_b32 s19, s19, 0
s_mov_b64 exec, 1
v_mov_b32 v4, s19
v_mov_b32 v5, 24576
ds_write_b32 v5, v4
s_mov_b64 exec, -1
s_barrier
s_waitcnt lgkmcnt(0)
s_barrier
s_barrier
s_barrier
s_barrier
s_mov_b64 exec, 0xfff
s_mov_b32 s46, 1000000
L_poll_h0:
buffer_load_dwordx2 v[12:13], v9, s[36:39], 0 offen offset:0 sc1
s_waitcnt vmcnt(0)
v_cmp_ne_u64 vcc, v[12:13], v[10:11]
s_sub_u32 s46, s46, 1
s_cmp_eq_u32 s46, 0
s_cbranch_scc1 L_polldone_h0
s_nop 1
s_cbranch_vccz L_polldone_h0
s_sleep 1
s_branch L_poll_h0
L_polldone_h0:
s_mov_b64 exec, -1
s_barrier
s_barrier
s_barrier
s_mov_b64 exec, 0xfff
s_mov_b32 s46, 1000000
L_poll_h1:
buffer_load_dwordx2 v[12:13], v9, s[36:39], 0 offen offset:32 sc1
s_waitcnt vmcnt(0)
v_cmp_ne_u64 vcc, v[12:13], v[10:11]
s_sub_u32 s46, s46, 1
s_cmp_eq_u32 s46, 0
s_cbranch_scc1 L_polldone_h1
s_nop 1
s_cbranch_vccz L_polldone_h1
s_sleep 1
s_branch L_poll_h1
L_polldone_h1:
s_mov_b64 exec, -1
s_barrier
s_barrier
s_mov_b64 exec, 0xfff
s_mov_b32 s46, 1000000
L_poll_h2:
buffer_load_dwordx2 v[12:13], v9, s[36:39], 0 offen offset:64 sc1
s_waitcnt vmcnt(0)
v_cmp_ne_u64 vcc, v[12:13], v[10:11]
s_sub_u32 s46, s46, 1
s_cmp_eq_u32 s46, 0
s_cbranch_scc1 L_polldone_h2
s_nop 1
s_cbranch_vccz L_polldone_h2
s_sleep 1
s_branch L_poll_h2
L_polldone_h2:
s_mov_b64 exec, -1
s_barrier
s_barrier
s_barrier
s_barrier
s_barrier
s_branch L_gather
L_prefetch:
s_sub_u32 s52, s3, 24
s_cmp_ge_u32 s17, 4
s_cbranch_scc1 L_pf_h
v_min_u32 v1, 215, v0
s_mov_b32 s22, 21846
v_mul_u32_u24 v2, s22, v1
v_lshrrev_b32 v2, 16, v2
v_mul_u32_u24 v3, 3, v2
v_sub_u32 v3, v1, v3
v_mul_u32_u24 v4, 9216, v2
v_mul_u32_u24 v3, 384, v3
v_add_u32 v4, v4, v3
s_mul_i32 s53, s52, 663552
s_mul_i32 s23, s14, 1152
s_add_u32 s53, s53, s23
s_add_u32 s53, s53, 128
s_mov_b32 s22, 7282
v_mul_u32_u24 v5, s22, v1
v_lshrrev_b32 v5, 16, v5
v_mul_u32_u24 v6, 9, v5
v_sub_u32 v6, v1, v6
s_mul_i32 s54, s52, 24
v_add_u32 v5, s54, v5
v_lshrrev_b32 v7, 6, v5
v_and_b32 v5, 63, v5
v_mul_u32_u24 v7, 192, v7
v_add_u32 v5, v5, v7
v_mul_u32_u24 v5, 1152, v5
v_lshl_add_u32 v5, v6, 7, v5
s_mul_i32 s55, s14, 663552
s_waitcnt lgkmcnt(0)
s_mov_b32 s28, s6
s_and_b32 s29, s7, 0xffff
s_mov_b32 s30, 5308416
s_mov_b32 s31, 0x20000
s_mov_b32 s32, s8
s_and_b32 s33, s9, 0xffff
s_mov_b32 s34, 5308416
s_mov_b32 s35, 0x20000
s_sub_u32 s56, s53, 128
buffer_load_dword v8, v4, s[28:31], s56 offen
s_waitcnt vmcnt(0)
s_mov_b32 s24, s4
s_and_b32 s25, s5, 0xffff
s_mov_b32 s26, 589824
s_mov_b32 s27, 0x20000
s_mul_i32 s56, s52, 73728
s_add_u32 s56, s56, 0
v_lshlrev_b32 v9, 7, v1
buffer_load_dword v8, v9, s[24:27], s56 offen
s_waitcnt vmcnt(0)
s_add_u32 s56, s53, 0
buffer_load_dword v8, v4, s[28:31], s56 offen
s_waitcnt vmcnt(0)
s_add_u32 s56, s53, 128
buffer_load_dword v8, v4, s[28:31], s56 offen
s_waitcnt vmcnt(0)
s_add_u32 s56, s55, 0
buffer_load_dword v8, v5, s[32:35], s56 offen
s_add_u32 s56, s55, 73728
buffer_load_dword v9, v5, s[32:35], s56 offen
s_waitcnt vmcnt(0)
s_add_u32 s56, s55, 147456
buffer_load_dword v8, v5, s[32:35], s56 offen
s_waitcnt vmcnt(0)
s_endpgm
L_pf_h:
v_subrev_u32 v1, 256, v0
v_min_u32 v1, 191, v1
v_lshrrev_b32 v2, 6, v1
v_and_b32 v3, 63, v1
v_mul_u32_u24 v2, 24576, v2
v_lshl_add_u32 v2, v3, 7, v2
s_mul_i32 s53, s14, 589824
s_mul_i32 s54, s52, 73728
s_add_u32 s53, s53, s54
s_add_u32 s53, s53, 262144
v_and_b32 v4, 63, v3
v_mul_u32_u24 v4, 9216, v4
s_mul_i32 s54, s52, 663552
s_mul_i32 s55, s14, 1152
s_add_u32 s54, s54, s55
s_waitcnt lgkmcnt(0)
s_mov_b32 s28, s6
s_and_b32 s29, s7, 0xffff
s_mov_b32 s30, 5308416
s_mov_b32 s31, 0x20000
s_mov_b32 s36, s12
s_and_b32 s37, s13, 0xffff
s_mov_b32 s38, 268435456
s_mov_b32 s39, 0x20000
s_mov_b32 s24, s4
s_and_b32 s25, s5, 0xffff
s_mov_b32 s26, 589824
s_mov_b32 s27, 0x20000
v_lshlrev_b32 v9, 7, v1
s_mul_i32 s56, s52, 73728
buffer_load_dword v8, v4, s[28:31], s54 offen
s_waitcnt vmcnt(0)
s_add_u32 s57, s56, 27648
buffer_load_dword v8, v9, s[24:27], s57 offen
s_waitcnt vmcnt(0)
s_add_u32 s57, s56, 52224
buffer_load_dword v8, v9, s[24:27], s57 offen
s_waitcnt vmcnt(0)
buffer_load_dword v8, v2, s[36:39], s53 offen
s_waitcnt vmcnt(0)
s_add_u32 s53, s53, 8192
buffer_load_dword v8, v2, s[36:39], s53 offen
s_waitcnt vmcnt(0)
s_add_u32 s53, s53, 8192
buffer_load_dword v8, v2, s[36:39], s53 offen
s_waitcnt vmcnt(0)
s_endpgm
L_compute:
s_add_u32 s44, s16, 1
s_cmp_eq_u32 s44, 3
s_cselect_b32 s44, 0, s44
s_add_u32 s45, s44, 1
s_cmp_eq_u32 s45, 3
s_cselect_b32 s45, 0, s45
s_lshl_b32 s18, s14, 3
s_add_u32 s18, s18, s15
s_mul_i32 s18, s18, 3
s_add_u32 s18, s18, s16
s_lshl_b32 s3, s15, 7
s_lshr_b32 s48, s17, 1
s_and_b32 s49, s17, 1
s_mov_b32 s51, 0xbfb8aa3b
v_lshrrev_b32 v20, 5, v0
v_lshrrev_b32 v21, 4, v0
v_and_b32 v21, 1, v21
v_and_b32 v22, 15, v0
v_lshrrev_b32 v23, 2, v22
v_and_b32 v22, 3, v22
v_lshrrev_b32 v24, 1, v22
v_lshl_add_u32 v24, v21, 1, v24
s_lshl_b32 s22, s49, 2
v_add_u32 v24, s22, v24
v_and_b32 v25, 2, v23
v_lshlrev_b32 v25, 1, v25
v_xor_b32 v24, v24, v25
v_lshlrev_b32 v24, 4, v24
v_and_b32 v22, 1, v22
v_lshl_add_u32 v24, v22, 3, v24
v_lshl_add_u32 v24, v23, 7, v24
v_add_u32 v24, 73728, v24
v_lshl_add_u32 v2, v20, 10, v24
v_lshl_add_u32 v4, v20, 9, v24
v_add_u32 v3, 65536, v2
v_add_u32 v5, 65536, v4
v_and_b32 v25, 31, v0
v_lshrrev_b32 v26, 1, v25
v_and_b32 v26, 7, v26
v_xor_b32 v26, v20, v26
v_lshlrev_b32 v26, 4, v26
s_lshl_b32 s23, s48, 12
v_lshl_add_u32 v26, v25, 7, v26
v_add_u32 v6, s23, v26
v_xor_b32 v7, 32, v6
v_xor_b32 v8, 64, v6
v_xor_b32 v9, 96, v6
v_add_u32 v10, 65536, v6
v_add_u32 v11, 65536, v7
v_add_u32 v12, 65536, v8
v_add_u32 v13, 65536, v9
v_lshlrev_b32 v27, 4, v0
v_add_u32 v14, s23, v27
v_add_u32 v15, 65536, v14
s_lshl_b32 s22, s49, 11
v_add_u32 v17, s22, v14
s_mul_i32 s50, s18, 24576
s_add_u32 s50, s50, 262144
s_lshl_b32 s22, s18, 7
s_lshl_b32 s23, s17, 3
s_add_u32 s22, s22, s23
s_add_u32 s22, s22, 32768
v_mov_b32 v1, s22
s_mul_i32 s22, s15, 3
s_add_u32 s22, s22, s16
s_lshl_b32 s23, s48, 2
s_mul_i32 s23, s23, 24
s_add_u32 s22, s22, s23
s_mul_i32 s52, s22, 24576
s_mul_i32 s23, s14, 3072
s_add_u32 s52, s52, s23
s_lshl_b32 s23, s49, 9
s_add_u32 s52, s52, s23
s_add_u32 s52, s52, 5242880
s_add_u32 s53, s52, 1179648
s_mul_i32 s22, s22, 384
s_lshl_b32 s23, s14, 1
s_add_u32 s23, s23, s49
s_mul_i32 s23, s23, 8
s_add_u32 s22, s22, s23
s_add_u32 s54, s22, 65536
v_mov_b32 v16, 24576
s_waitcnt lgkmcnt(0)
s_load_dwordx2 s[20:21], s[12:13], s3
s_mov_b32 s36, s12
s_and_b32 s37, s13, 0xffff
s_mov_b32 s38, 268435456
s_mov_b32 s39, 0x20000
s_mov_b32 s40, s10
s_and_b32 s41, s11, 0xffff
s_mov_b32 s42, 589824
s_mov_b32 s43, 0x20000
s_waitcnt lgkmcnt(0)
s_add_u32 s20, s20, 0x7f4a7c15
s_addc_u32 s21, s21, 0x9e3779b9
v_mov_b32 v18, s20
v_mov_b32 v19, s21
s_waitcnt vmcnt(0)
s_waitcnt lgkmcnt(0)
s_barrier
ds_read_b64_tr_b16 v[32:33], v2 offset:0
ds_read_b64_tr_b16 v[34:35], v2 offset:512
ds_read_b64_tr_b16 v[36:37], v2 offset:2048
ds_read_b64_tr_b16 v[38:39], v2 offset:2560
ds_read_b128 v[112:115], v6 offset:0
ds_read_b128 v[116:119], v7 offset:0
ds_read_b64_tr_b16 v[40:41], v2 offset:4096
ds_read_b64_tr_b16 v[42:43], v2 offset:4608
ds_read_b64_tr_b16 v[44:45], v2 offset:6144
ds_read_b64_tr_b16 v[46:47], v2 offset:6656
ds_read_b128 v[120:123], v8 offset:0
ds_read_b128 v[124:127], v9 offset:0
ds_read_b64_tr_b16 v[48:49], v2 offset:8192
ds_read_b64_tr_b16 v[50:51], v2 offset:8704
ds_read_b64_tr_b16 v[52:53], v2 offset:10240
ds_read_b64_tr_b16 v[54:55], v2 offset:10752
ds_read_b128 v[128:131], v6 offset:8192
ds_read_b128 v[132:135], v7 offset:8192
ds_read_b64_tr_b16 v[56:57], v2 offset:12288
ds_read_b64_tr_b16 v[58:59], v2 offset:12800
ds_read_b64_tr_b16 v[60:61], v2 offset:14336
ds_read_b64_tr_b16 v[62:63], v2 offset:14848
s_waitcnt lgkmcnt(15)
v_mfma_f32_32x32x16_bf16 v[64:79], v[32:35], v[112:115], 0
ds_read_b128 v[136:139], v8 offset:8192
ds_read_b128 v[140:143], v9 offset:8192
v_mfma_f32_32x32x16_bf16 v[64:79], v[36:39], v[116:119], v[64:79]
ds_read_b64_tr_b16 v[32:33], v2 offset:16384
ds_read_b64_tr_b16 v[34:35], v2 offset:16896
ds_read_b64_tr_b16 v[36:37], v2 offset:18432
ds_read_b64_tr_b16 v[38:39], v2 offset:18944
s_waitcnt lgkmcnt(15)
v_mfma_f32_32x32x16_bf16 v[64:79], v[40:43], v[120:123], v[64:79]
ds_read_b128 v[144:147], v6 offset:16384
ds_read_b128 v[148:151], v7 offset:16384
v_mfma_f32_32x32x16_bf16 v[64:79], v[44:47], v[124:127], v[64:79]
ds_read_b64_tr_b16 v[40:41], v2 offset:20480
ds_read_b64_tr_b16 v[42:43], v2 offset:20992
ds_read_b64_tr_b16 v[44:45], v2 offset:22528
ds_read_b64_tr_b16 v[46:47], v2 offset:23040
s_waitcnt lgkmcnt(15)
v_mfma_f32_32x32x16_bf16 v[64:79], v[48:51], v[128:131], v[64:79]
ds_read_b128 v[152:155], v8 offset:16384
ds_read_b128 v[156:159], v9 offset:16384
v_mfma_f32_32x32x16_bf16 v[64:79], v[52:55], v[132:135], v[64:79]
s_waitcnt lgkmcnt(0)
s_barrier
v_mfma_f32_32x32x16_bf16 v[64:79], v[56:59], v[136:139], v[64:79]
ds_read_b64_tr_b16 v[48:49], v2 offset:24576
ds_read_b64_tr_b16 v[50:51], v2 offset:25088
ds_read_b64_tr_b16 v[52:53], v2 offset:26624
ds_read_b64_tr_b16 v[54:55], v2 offset:27136
ds_read_b128 v[160:163], v6 offset:24576
ds_read_b128 v[164:167], v7 offset:24576
v_mfma_f32_32x32x16_bf16 v[64:79], v[60:63], v[140:143], v[64:79]
ds_read_b64_tr_b16 v[56:57], v2 offset:28672
ds_read_b64_tr_b16 v[58:59], v2 offset:29184
ds_read_b64_tr_b16 v[60:61], v2 offset:30720
ds_read_b64_tr_b16 v[62:63], v2 offset:31232
v_mfma_f32_32x32x16_bf16 v[64:79], v[32:35], v[144:147], v[64:79]
ds_read_b128 v[168:171], v8 offset:24576
ds_read_b128 v[172:175], v9 offset:24576
v_mfma_f32_32x32x16_bf16 v[64:79], v[36:39], v[148:151], v[64:79]
ds_read_b64_tr_b16 v[32:33], v2 offset:32768
ds_read_b64_tr_b16 v[34:35], v2 offset:33280
ds_read_b64_tr_b16 v[36:37], v2 offset:34816
ds_read_b64_tr_b16 v[38:39], v2 offset:35328
v_mfma_f32_32x32x16_bf16 v[64:79], v[40:43], v[152:155], v[64:79]
ds_read_b128 v[176:179], v6 offset:32768
ds_read_b128 v[180:183], v7 offset:32768
v_mfma_f32_32x32x16_bf16 v[64:79], v[44:47], v[156:159], v[64:79]
ds_read_b64_tr_b16 v[40:41], v2 offset:36864
ds_read_b64_tr_b16 v[42:43], v2 offset:37376
ds_read_b64_tr_b16 v[44:45], v2 offset:38912
ds_read_b64_tr_b16 v[46:47], v2 offset:39424
s_waitcnt lgkmcnt(15)
v_mfma_f32_32x32x16_bf16 v[64:79], v[48:51], v[160:163], v[64:79]
ds_read_b128 v[184:187], v8 offset:32768
ds_read_b128 v[188:191], v9 offset:32768
v_mfma_f32_32x32x16_bf16 v[64:79], v[52:55], v[164:167], v[64:79]
ds_read_b64_tr_b16 v[48:49], v2 offset:40960
ds_read_b64_tr_b16 v[50:51], v2 offset:41472
ds_read_b64_tr_b16 v[52:53], v2 offset:43008
ds_read_b64_tr_b16 v[54:55], v2 offset:43520
s_waitcnt lgkmcnt(15)
v_mfma_f32_32x32x16_bf16 v[64:79], v[56:59], v[168:171], v[64:79]
ds_read_b128 v[192:195], v6 offset:40960
ds_read_b128 v[196:199], v7 offset:40960
v_mfma_f32_32x32x16_bf16 v[64:79], v[60:63], v[172:175], v[64:79]
ds_read_b64_tr_b16 v[56:57], v2 offset:45056
ds_read_b64_tr_b16 v[58:59], v2 offset:45568
ds_read_b64_tr_b16 v[60:61], v2 offset:47104
ds_read_b64_tr_b16 v[62:63], v2 offset:47616
s_waitcnt lgkmcnt(15)
v_mfma_f32_32x32x16_bf16 v[64:79], v[32:35], v[176:179], v[64:79]
ds_read_b128 v[200:203], v8 offset:40960
ds_read_b128 v[204:207], v9 offset:40960
v_mfma_f32_32x32x16_bf16 v[64:79], v[36:39], v[180:183], v[64:79]
s_waitcnt lgkmcnt(0)
s_barrier
v_mfma_f32_32x32x16_bf16 v[64:79], v[40:43], v[184:187], v[64:79]
ds_read_b64_tr_b16 v[32:33], v2 offset:49152
ds_read_b64_tr_b16 v[34:35], v2 offset:49664
ds_read_b64_tr_b16 v[36:37], v2 offset:51200
ds_read_b64_tr_b16 v[38:39], v2 offset:51712
ds_read_b128 v[208:211], v6 offset:49152
ds_read_b128 v[212:215], v7 offset:49152
v_mfma_f32_32x32x16_bf16 v[64:79], v[44:47], v[188:191], v[64:79]
ds_read_b64_tr_b16 v[40:41], v2 offset:53248
ds_read_b64_tr_b16 v[42:43], v2 offset:53760
ds_read_b64_tr_b16 v[44:45], v2 offset:55296
ds_read_b64_tr_b16 v[46:47], v2 offset:55808
v_mfma_f32_32x32x16_bf16 v[64:79], v[48:51], v[192:195], v[64:79]
ds_read_b128 v[216:219], v8 offset:49152
ds_read_b128 v[220:223], v9 offset:49152
v_mfma_f32_32x32x16_bf16 v[64:79], v[52:55], v[196:199], v[64:79]
ds_read_b64_tr_b16 v[48:49], v2 offset:57344
ds_read_b64_tr_b16 v[50:51], v2 offset:57856
ds_read_b64_tr_b16 v[52:53], v2 offset:59392
ds_read_b64_tr_b16 v[54:55], v2 offset:59904
v_mfma_f32_32x32x16_bf16 v[64:79], v[56:59], v[200:203], v[64:79]
ds_read_b128 v[224:227], v6 offset:57344
ds_read_b128 v[228:231], v7 offset:57344
v_mfma_f32_32x32x16_bf16 v[64:79], v[60:63], v[204:207], v[64:79]
ds_read_b64_tr_b16 v[56:57], v2 offset:61440
ds_read_b64_tr_b16 v[58:59], v2 offset:61952
ds_read_b64_tr_b16 v[60:61], v2 offset:63488
ds_read_b64_tr_b16 v[62:63], v2 offset:64000
s_waitcnt lgkmcnt(15)
v_mfma_f32_32x32x16_bf16 v[64:79], v[32:35], v[208:211], v[64:79]
ds_read_b128 v[232:235], v8 offset:57344
ds_read_b128 v[236:239], v9 offset:57344
v_mfma_f32_32x32x16_bf16 v[64:79], v[36:39], v[212:215], v[64:79]
ds_read_b64_tr_b16 v[32:33], v3 offset:0
ds_read_b64_tr_b16 v[34:35], v3 offset:512
ds_read_b64_tr_b16 v[36:37], v3 offset:2048
ds_read_b64_tr_b16 v[38:39], v3 offset:2560
s_waitcnt lgkmcnt(15)
v_mfma_f32_32x32x16_bf16 v[64:79], v[40:43], v[216:219], v[64:79]
ds_read_b128 v[240:243], v10 offset:0
ds_read_b128 v[244:247], v11 offset:0
v_mfma_f32_32x32x16_bf16 v[64:79], v[44:47], v[220:223], v[64:79]
ds_read_b64_tr_b16 v[40:41], v3 offset:4096
ds_read_b64_tr_b16 v[42:43], v3 offset:4608
ds_read_b64_tr_b16 v[44:45], v3 offset:6144
ds_read_b64_tr_b16 v[46:47], v3 offset:6656
s_waitcnt lgkmcnt(15)
v_mfma_f32_32x32x16_bf16 v[64:79], v[48:51], v[224:227], v[64:79]
ds_read_b128 v[248:251], v12 offset:0
ds_read_b128 v[252:255], v13 offset:0
v_mfma_f32_32x32x16_bf16 v[64:79], v[52:55], v[228:231], v[64:79]
s_waitcnt lgkmcnt(0)
s_barrier
v_mfma_f32_32x32x16_bf16 v[64:79], v[56:59], v[232:235], v[64:79]
ds_read_b64_tr_b16 v[48:49], v3 offset:8192
ds_read_b64_tr_b16 v[50:51], v3 offset:8704
ds_read_b64_tr_b16 v[52:53], v3 offset:10240
ds_read_b64_tr_b16 v[54:55], v3 offset:10752
v_mfma_f32_32x32x16_bf16 v[64:79], v[60:63], v[236:239], v[64:79]
ds_read_b64_tr_b16 v[56:57], v3 offset:12288
ds_read_b64_tr_b16 v[58:59], v3 offset:12800
ds_read_b64_tr_b16 v[60:61], v3 offset:14336
ds_read_b64_tr_b16 v[62:63], v3 offset:14848
v_mfma_f32_32x32x16_bf16 v[64:79], v[32:35], v[240:243], v[64:79]
v_mfma_f32_32x32x16_bf16 v[64:79], v[36:39], v[244:247], v[64:79]
ds_read_b64_tr_b16 v[32:33], v3 offset:16384
ds_read_b64_tr_b16 v[34:35], v3 offset:16896
ds_read_b64_tr_b16 v[36:37], v3 offset:18432
ds_read_b64_tr_b16 v[38:39], v3 offset:18944
v_mfma_f32_32x32x16_bf16 v[64:79], v[40:43], v[248:251], v[64:79]
s_waitcnt lgkmcnt(8)
v_mfma_f32_32x32x16_bf16 v[64:79], v[44:47], v[252:255], v[64:79]
ds_read_b64_tr_b16 v[40:41], v3 offset:20480
ds_read_b64_tr_b16 v[42:43], v3 offset:20992
ds_read_b64_tr_b16 v[44:45], v3 offset:22528
ds_read_b64_tr_b16 v[46:47], v3 offset:23040
v_mfma_f32_32x32x16_bf16 v[80:95], v[48:51], v[112:115], 0
s_waitcnt lgkmcnt(8)
v_mfma_f32_32x32x16_bf16 v[80:95], v[52:55], v[116:119], v[80:95]
ds_read_b64_tr_b16 v[48:49], v2 offset:0
ds_read_b64_tr_b16 v[50:51], v2 offset:512
ds_read_b64_tr_b16 v[52:53], v2 offset:2048
ds_read_b64_tr_b16 v[54:55], v2 offset:2560
v_mfma_f32_32x32x16_bf16 v[80:95], v[56:59], v[120:123], v[80:95]
v_mul_f32 v20, s51, v64
v_mul_f32 v21, s51, v65
v_mul_f32 v22, s51, v66
v_mul_f32 v23, s51, v67
v_exp_f32 v20, v20
v_exp_f32 v21, v21
v_exp_f32 v22, v22
v_exp_f32 v23, v23
v_add_f32 v20, 1.0, v20
v_add_f32 v21, 1.0, v21
v_add_f32 v22, 1.0, v22
v_add_f32 v23, 1.0, v23
v_rcp_f32 v20, v20
v_rcp_f32 v21, v21
s_waitcnt lgkmcnt(8)
v_mfma_f32_32x32x16_bf16 v[80:95], v[60:63], v[124:127], v[80:95]
ds_read_b64_tr_b16 v[56:57], v2 offset:4096
ds_read_b64_tr_b16 v[58:59], v2 offset:4608
ds_read_b64_tr_b16 v[60:61], v2 offset:6144
ds_read_b64_tr_b16 v[62:63], v2 offset:6656
v_mfma_f32_32x32x16_bf16 v[80:95], v[32:35], v[128:131], v[80:95]
v_rcp_f32 v22, v22
v_rcp_f32 v23, v23
v_mul_f32 v64, v64, v20
v_mul_f32 v65, v65, v21
v_mul_f32 v66, v66, v22
v_mul_f32 v67, v67, v23
v_cvt_pk_bf16_f32 v24, v64, v65
v_cvt_pk_bf16_f32 v25, v66, v67
v_mul_f32 v20, s51, v68
v_mul_f32 v21, s51, v69
v_mul_f32 v22, s51, v70
v_mul_f32 v23, s51, v71
v_exp_f32 v20, v20
v_exp_f32 v21, v21
v_exp_f32 v22, v22
s_waitcnt lgkmcnt(8)
v_mfma_f32_32x32x16_bf16 v[80:95], v[36:39], v[132:135], v[80:95]
s_waitcnt lgkmcnt(0)
s_barrier
v_mfma_f32_32x32x16_bf16 v[80:95], v[40:43], v[136:139], v[80:95]
ds_read_b32 v16, v16
ds_read_b64_tr_b16 v[32:33], v2 offset:8192
ds_read_b64_tr_b16 v[34:35], v2 offset:8704
ds_read_b64_tr_b16 v[36:37], v2 offset:10240
ds_read_b64_tr_b16 v[38:39], v2 offset:10752
v_mfma_f32_32x32x16_bf16 v[80:95], v[44:47], v[140:143], v[80:95]
ds_read_b64_tr_b16 v[40:41], v2 offset:12288
ds_read_b64_tr_b16 v[42:43], v2 offset:12800
ds_read_b64_tr_b16 v[44:45], v2 offset:14336
ds_read_b64_tr_b16 v[46:47], v2 offset:14848
v_mfma_f32_32x32x16_bf16 v[80:95], v[48:51], v[144:147], v[80:95]
v_exp_f32 v23, v23
v_add_f32 v20, 1.0, v20
v_add_f32 v21, 1.0, v21
v_add_f32 v22, 1.0, v22
v_add_f32 v23, 1.0, v23
v_rcp_f32 v20, v20
v_rcp_f32 v21, v21
v_rcp_f32 v22, v22
v_rcp_f32 v23, v23
v_mul_f32 v68, v68, v20
v_mul_f32 v69, v69, v21
v_mul_f32 v70, v70, v22
v_mul_f32 v71, v71, v23
v_cvt_pk_bf16_f32 v26, v68, v69
v_cvt_pk_bf16_f32 v27, v70, v71
v_mfma_f32_32x32x16_bf16 v[80:95], v[52:55], v[148:151], v[80:95]
ds_read_b64_tr_b16 v[48:49], v2 offset:16384
ds_read_b64_tr_b16 v[50:51], v2 offset:16896
ds_read_b64_tr_b16 v[52:53], v2 offset:18432
ds_read_b64_tr_b16 v[54:55], v2 offset:18944
v_mfma_f32_32x32x16_bf16 v[80:95], v[56:59], v[152:155], v[80:95]
v_mul_f32 v20, s51, v72
v_mul_f32 v21, s51, v73
v_mul_f32 v22, s51, v74
v_mul_f32 v23, s51, v75
v_exp_f32 v20, v20
v_exp_f32 v21, v21
v_exp_f32 v22, v22
v_exp_f32 v23, v23
v_add_f32 v20, 1.0, v20
v_add_f32 v21, 1.0, v21
v_add_f32 v22, 1.0, v22
v_add_f32 v23, 1.0, v23
v_rcp_f32 v20, v20
v_rcp_f32 v21, v21
s_waitcnt lgkmcnt(8)
v_mfma_f32_32x32x16_bf16 v[80:95], v[60:63], v[156:159], v[80:95]
ds_read_b64_tr_b16 v[56:57], v2 offset:20480
ds_read_b64_tr_b16 v[58:59], v2 offset:20992
ds_read_b64_tr_b16 v[60:61], v2 offset:22528
ds_read_b64_tr_b16 v[62:63], v2 offset:23040
v_mfma_f32_32x32x16_bf16 v[80:95], v[32:35], v[160:163], v[80:95]
v_rcp_f32 v22, v22
v_rcp_f32 v23, v23
v_mul_f32 v72, v72, v20
v_mul_f32 v73, v73, v21
v_mul_f32 v74, v74, v22
v_mul_f32 v75, v75, v23
v_cvt_pk_bf16_f32 v28, v72, v73
v_cvt_pk_bf16_f32 v29, v74, v75
v_mul_f32 v20, s51, v76
v_mul_f32 v21, s51, v77
v_mul_f32 v22, s51, v78
v_mul_f32 v23, s51, v79
v_exp_f32 v20, v20
v_exp_f32 v21, v21
v_exp_f32 v22, v22
s_waitcnt lgkmcnt(8)
v_mfma_f32_32x32x16_bf16 v[80:95], v[36:39], v[164:167], v[80:95]
v_readfirstlane_b32 s19, v16
ds_read_b64_tr_b16 v[32:33], v2 offset:24576
ds_read_b64_tr_b16 v[34:35], v2 offset:25088
ds_read_b64_tr_b16 v[36:37], v2 offset:26624
ds_read_b64_tr_b16 v[38:39], v2 offset:27136
v_mfma_f32_32x32x16_bf16 v[80:95], v[40:43], v[168:171], v[80:95]
v_exp_f32 v23, v23
v_add_f32 v20, 1.0, v20
v_add_f32 v21, 1.0, v21
v_add_f32 v22, 1.0, v22
v_add_f32 v23, 1.0, v23
v_rcp_f32 v20, v20
v_rcp_f32 v21, v21
v_rcp_f32 v22, v22
v_rcp_f32 v23, v23
v_mul_f32 v76, v76, v20
v_mul_f32 v77, v77, v21
v_mul_f32 v78, v78, v22
v_mul_f32 v79, v79, v23
v_cvt_pk_bf16_f32 v30, v76, v77
v_cvt_pk_bf16_f32 v31, v78, v79
s_waitcnt lgkmcnt(8)
v_mfma_f32_32x32x16_bf16 v[80:95], v[44:47], v[172:175], v[80:95]
ds_read_b64_tr_b16 v[40:41], v2 offset:28672
ds_read_b64_tr_b16 v[42:43], v2 offset:29184
ds_read_b64_tr_b16 v[44:45], v2 offset:30720
ds_read_b64_tr_b16 v[46:47], v2 offset:31232
v_mfma_f32_32x32x16_bf16 v[80:95], v[48:51], v[176:179], v[80:95]
s_cmp_eq_u32 s19, 0
s_cbranch_scc1 L_ds1
buffer_store_dwordx4 v[24:27], v17, s[36:39], s50 offen offset:0 nt
L_dd1:
s_cmp_eq_u32 s19, 0
s_cbranch_scc1 L_ds2
buffer_store_dwordx4 v[28:31], v17, s[36:39], s50 offen offset:1024 nt
L_dd2:
s_add_u32 s50, s50, 8192
s_waitcnt lgkmcnt(8)
v_mfma_f32_32x32x16_bf16 v[80:95], v[52:55], v[180:183], v[80:95]
s_waitcnt lgkmcnt(0)
s_barrier
v_mfma_f32_32x32x16_bf16 v[80:95], v[56:59], v[184:187], v[80:95]
ds_read_b64_tr_b16 v[48:49], v2 offset:32768
ds_read_b64_tr_b16 v[50:51], v2 offset:33280
ds_read_b64_tr_b16 v[52:53], v2 offset:34816
ds_read_b64_tr_b16 v[54:55], v2 offset:35328
v_mfma_f32_32x32x16_bf16 v[80:95], v[60:63], v[188:191], v[80:95]
ds_read_b64_tr_b16 v[56:57], v2 offset:36864
ds_read_b64_tr_b16 v[58:59], v2 offset:37376
ds_read_b64_tr_b16 v[60:61], v2 offset:38912
ds_read_b64_tr_b16 v[62:63], v2 offset:39424
v_mfma_f32_32x32x16_bf16 v[80:95], v[32:35], v[192:195], v[80:95]
v_mfma_f32_32x32x16_bf16 v[80:95], v[36:39], v[196:199], v[80:95]
ds_read_b64_tr_b16 v[32:33], v2 offset:40960
ds_read_b64_tr_b16 v[34:35], v2 offset:41472
ds_read_b64_tr_b16 v[36:37], v2 offset:43008
ds_read_b64_tr_b16 v[38:39], v2 offset:43520
v_mfma_f32_32x32x16_bf16 v[80:95], v[40:43], v[200:203], v[80:95]
s_waitcnt lgkmcnt(8)
v_mfma_f32_32x32x16_bf16 v[80:95], v[44:47], v[204:207], v[80:95]
ds_read_b64_tr_b16 v[40:41], v2 offset:45056
ds_read_b64_tr_b16 v[42:43], v2 offset:45568
ds_read_b64_tr_b16 v[44:45], v2 offset:47104
ds_read_b64_tr_b16 v[46:47], v2 offset:47616
v_mfma_f32_32x32x16_bf16 v[80:95], v[48:51], v[208:211], v[80:95]
s_waitcnt lgkmcnt(8)
v_mfma_f32_32x32x16_bf16 v[80:95], v[52:55], v[212:215], v[80:95]
ds_read_b64_tr_b16 v[48:49], v2 offset:49152
ds_read_b64_tr_b16 v[50:51], v2 offset:49664
ds_read_b64_tr_b16 v[52:53], v2 offset:51200
ds_read_b64_tr_b16 v[54:55], v2 offset:51712
v_mfma_f32_32x32x16_bf16 v[80:95], v[56:59], v[216:219], v[80:95]
s_waitcnt vmcnt(0)
s_mov_b64 exec, 1
s_cmp_eq_u32 s19, 0
s_cbranch_scc1 L_ds3
buffer_store_dwordx2 v[18:19], v1, s[36:39], 0 offen offset:0
L_dd3:
s_mov_b64 exec, -1
s_waitcnt lgkmcnt(8)
v_mfma_f32_32x32x16_bf16 v[80:95], v[60:63], v[220:223], v[80:95]
ds_read_b64_tr_b16 v[56:57], v2 offset:53248
ds_read_b64_tr_b16 v[58:59], v2 offset:53760
ds_read_b64_tr_b16 v[60:61], v2 offset:55296
ds_read_b64_tr_b16 v[62:63], v2 offset:55808
v_mfma_f32_32x32x16_bf16 v[80:95], v[32:35], v[224:227], v[80:95]
s_waitcnt lgkmcnt(8)
v_mfma_f32_32x32x16_bf16 v[80:95], v[36:39], v[228:231], v[80:95]
s_waitcnt lgkmcnt(0)
s_barrier
v_mfma_f32_32x32x16_bf16 v[80:95], v[40:43], v[232:235], v[80:95]
ds_read_b64_tr_b16 v[32:33], v2 offset:57344
ds_read_b64_tr_b16 v[34:35], v2 offset:57856
ds_read_b64_tr_b16 v[36:37], v2 offset:59392
ds_read_b64_tr_b16 v[38:39], v2 offset:59904
v_mfma_f32_32x32x16_bf16 v[80:95], v[44:47], v[236:239], v[80:95]
ds_read_b64_tr_b16 v[40:41], v2 offset:61440
ds_read_b64_tr_b16 v[42:43], v2 offset:61952
ds_read_b64_tr_b16 v[44:45], v2 offset:63488
ds_read_b64_tr_b16 v[46:47], v2 offset:64000
v_mfma_f32_32x32x16_bf16 v[80:95], v[48:51], v[240:243], v[80:95]
v_mfma_f32_32x32x16_bf16 v[80:95], v[52:55], v[244:247], v[80:95]
ds_read_b64_tr_b16 v[48:49], v3 offset:0
ds_read_b64_tr_b16 v[50:51], v3 offset:512
ds_read_b64_tr_b16 v[52:53], v3 offset:2048
ds_read_b64_tr_b16 v[54:55], v3 offset:2560
v_mfma_f32_32x32x16_bf16 v[80:95], v[56:59], v[248:251], v[80:95]
s_waitcnt lgkmcnt(8)
v_mfma_f32_32x32x16_bf16 v[80:95], v[60:63], v[252:255], v[80:95]
ds_read_b64_tr_b16 v[56:57], v3 offset:4096
ds_read_b64_tr_b16 v[58:59], v3 offset:4608
ds_read_b64_tr_b16 v[60:61], v3 offset:6144
ds_read_b64_tr_b16 v[62:63], v3 offset:6656
v_mfma_f32_32x32x16_bf16 v[64:79], v[32:35], v[112:115], 0
s_waitcnt lgkmcnt(8)
v_mfma_f32_32x32x16_bf16 v[64:79], v[36:39], v[116:119], v[64:79]
ds_read_b64_tr_b16 v[32:33], v3 offset:8192
ds_read_b64_tr_b16 v[34:35], v3 offset:8704
ds_read_b64_tr_b16 v[36:37], v3 offset:10240
ds_read_b64_tr_b16 v[38:39], v3 offset:10752
v_mfma_f32_32x32x16_bf16 v[64:79], v[40:43], v[120:123], v[64:79]
v_mul_f32 v20, s51, v80
v_mul_f32 v21, s51, v81
v_mul_f32 v22, s51, v82
v_mul_f32 v23, s51, v83
v_exp_f32 v20, v20
v_exp_f32 v21, v21
v_exp_f32 v22, v22
v_exp_f32 v23, v23
v_add_f32 v20, 1.0, v20
s_waitcnt lgkmcnt(8)
v_mfma_f32_32x32x16_bf16 v[64:79], v[44:47], v[124:127], v[64:79]
ds_read_b64_tr_b16 v[40:41], v3 offset:12288
ds_read_b64_tr_b16 v[42:43], v3 offset:12800
ds_read_b64_tr_b16 v[44:45], v3 offset:14336
ds_read_b64_tr_b16 v[46:47], v3 offset:14848
v_mfma_f32_32x32x16_bf16 v[64:79], v[48:51], v[128:131], v[64:79]
v_add_f32 v21, 1.0, v21
v_add_f32 v22, 1.0, v22
v_add_f32 v23, 1.0, v23
v_rcp_f32 v20, v20
v_rcp_f32 v21, v21
v_rcp_f32 v22, v22
v_rcp_f32 v23, v23
v_mul_f32 v80, v80, v20
v_mul_f32 v81, v81, v21
s_waitcnt lgkmcnt(8)
v_mfma_f32_32x32x16_bf16 v[64:79], v[52:55], v[132:135], v[64:79]
s_waitcnt lgkmcnt(0)
s_barrier
v_mfma_f32_32x32x16_bf16 v[64:79], v[56:59], v[136:139], v[64:79]
ds_read_b64_tr_b16 v[48:49], v3 offset:16384
ds_read_b64_tr_b16 v[50:51], v3 offset:16896
ds_read_b64_tr_b16 v[52:53], v3 offset:18432
ds_read_b64_tr_b16 v[54:55], v3 offset:18944
v_mfma_f32_32x32x16_bf16 v[64:79], v[60:63], v[140:143], v[64:79]
ds_read_b64_tr_b16 v[56:57], v3 offset:20480
ds_read_b64_tr_b16 v[58:59], v3 offset:20992
ds_read_b64_tr_b16 v[60:61], v3 offset:22528
ds_read_b64_tr_b16 v[62:63], v3 offset:23040
v_mfma_f32_32x32x16_bf16 v[64:79], v[32:35], v[144:147], v[64:79]
v_mul_f32 v82, v82, v22
v_mul_f32 v83, v83, v23
v_cvt_pk_bf16_f32 v24, v80, v81
v_cvt_pk_bf16_f32 v25, v82, v83
v_mul_f32 v20, s51, v84
v_mul_f32 v21, s51, v85
v_mul_f32 v22, s51, v86
v_mul_f32 v23, s51, v87
v_exp_f32 v20, v20
v_exp_f32 v21, v21
v_mfma_f32_32x32x16_bf16 v[64:79], v[36:39], v[148:151], v[64:79]
ds_read_b64_tr_b16 v[32:33], v2 offset:0
ds_read_b64_tr_b16 v[34:35], v2 offset:512
ds_read_b64_tr_b16 v[36:37], v2 offset:2048
ds_read_b64_tr_b16 v[38:39], v2 offset:2560
v_mfma_f32_32x32x16_bf16 v[64:79], v[40:43], v[152:155], v[64:79]
v_exp_f32 v22, v22
v_exp_f32 v23, v23
v_add_f32 v20, 1.0, v20
v_add_f32 v21, 1.0, v21
v_add_f32 v22, 1.0, v22
v_add_f32 v23, 1.0, v23
v_rcp_f32 v20, v20
v_rcp_f32 v21, v21
s_waitcnt lgkmcnt(8)
v_mfma_f32_32x32x16_bf16 v[64:79], v[44:47], v[156:159], v[64:79]
ds_read_b64_tr_b16 v[40:41], v2 offset:4096
ds_read_b64_tr_b16 v[42:43], v2 offset:4608
ds_read_b64_tr_b16 v[44:45], v2 offset:6144
ds_read_b64_tr_b16 v[46:47], v2 offset:6656
v_mfma_f32_32x32x16_bf16 v[64:79], v[48:51], v[160:163], v[64:79]
v_rcp_f32 v22, v22
v_rcp_f32 v23, v23
v_mul_f32 v84, v84, v20
v_mul_f32 v85, v85, v21
v_mul_f32 v86, v86, v22
v_mul_f32 v87, v87, v23
v_cvt_pk_bf16_f32 v26, v84, v85
v_cvt_pk_bf16_f32 v27, v86, v87
v_mul_f32 v20, s51, v88
v_mul_f32 v21, s51, v89
v_mul_f32 v22, s51, v90
s_waitcnt lgkmcnt(8)
v_mfma_f32_32x32x16_bf16 v[64:79], v[52:55], v[164:167], v[64:79]
ds_read_b64_tr_b16 v[48:49], v2 offset:8192
ds_read_b64_tr_b16 v[50:51], v2 offset:8704
ds_read_b64_tr_b16 v[52:53], v2 offset:10240
ds_read_b64_tr_b16 v[54:55], v2 offset:10752
v_mfma_f32_32x32x16_bf16 v[64:79], v[56:59], v[168:171], v[64:79]
v_mul_f32 v23, s51, v91
v_exp_f32 v20, v20
v_exp_f32 v21, v21
v_exp_f32 v22, v22
v_exp_f32 v23, v23
v_add_f32 v20, 1.0, v20
v_add_f32 v21, 1.0, v21
v_add_f32 v22, 1.0, v22
v_add_f32 v23, 1.0, v23
s_waitcnt lgkmcnt(8)
v_mfma_f32_32x32x16_bf16 v[64:79], v[60:63], v[172:175], v[64:79]
ds_read_b64_tr_b16 v[56:57], v2 offset:12288
ds_read_b64_tr_b16 v[58:59], v2 offset:12800
ds_read_b64_tr_b16 v[60:61], v2 offset:14336
ds_read_b64_tr_b16 v[62:63], v2 offset:14848
v_mfma_f32_32x32x16_bf16 v[64:79], v[32:35], v[176:179], v[64:79]
v_rcp_f32 v20, v20
v_rcp_f32 v21, v21
v_rcp_f32 v22, v22
v_rcp_f32 v23, v23
v_mul_f32 v88, v88, v20
v_mul_f32 v89, v89, v21
v_mul_f32 v90, v90, v22
v_mul_f32 v91, v91, v23
v_cvt_pk_bf16_f32 v28, v88, v89
s_waitcnt lgkmcnt(8)
v_mfma_f32_32x32x16_bf16 v[64:79], v[36:39], v[180:183], v[64:79]
s_waitcnt lgkmcnt(0)
s_barrier
v_mfma_f32_32x32x16_bf16 v[64:79], v[40:43], v[184:187], v[64:79]
ds_read_b64_tr_b16 v[32:33], v2 offset:16384
ds_read_b64_tr_b16 v[34:35], v2 offset:16896
ds_read_b64_tr_b16 v[36:37], v2 offset:18432
ds_read_b64_tr_b16 v[38:39], v2 offset:18944
v_mfma_f32_32x32x16_bf16 v[64:79], v[44:47], v[188:191], v[64:79]
ds_read_b64_tr_b16 v[40:41], v2 offset:20480
ds_read_b64_tr_b16 v[42:43], v2 offset:20992
ds_read_b64_tr_b16 v[44:45], v2 offset:22528
ds_read_b64_tr_b16 v[46:47], v2 offset:23040
v_mfma_f32_32x32x16_bf16 v[64:79], v[48:51], v[192:195], v[64:79]
v_cvt_pk_bf16_f32 v29, v90, v91
v_mul_f32 v20, s51, v92
v_mul_f32 v21, s51, v93
v_mul_f32 v22, s51, v94
v_mul_f32 v23, s51, v95
v_exp_f32 v20, v20
v_exp_f32 v21, v21
v_exp_f32 v22, v22
v_exp_f32 v23, v23
v_mfma_f32_32x32x16_bf16 v[64:79], v[52:55], v[196:199], v[64:79]
ds_read_b64_tr_b16 v[48:49], v2 offset:24576
ds_read_b64_tr_b16 v[50:51], v2 offset:25088
ds_read_b64_tr_b16 v[52:53], v2 offset:26624
ds_read_b64_tr_b16 v[54:55], v2 offset:27136
v_mfma_f32_32x32x16_bf16 v[64:79], v[56:59], v[200:203], v[64:79]
v_add_f32 v20, 1.0, v20
v_add_f32 v21, 1.0, v21
v_add_f32 v22, 1.0, v22
v_add_f32 v23, 1.0, v23
v_rcp_f32 v20, v20
v_rcp_f32 v21, v21
v_rcp_f32 v22, v22
v_rcp_f32 v23, v23
v_mul_f32 v92, v92, v20
s_waitcnt lgkmcnt(8)
v_mfma_f32_32x32x16_bf16 v[64:79], v[60:63], v[204:207], v[64:79]
ds_read_b64_tr_b16 v[56:57], v2 offset:28672
ds_read_b64_tr_b16 v[58:59], v2 offset:29184
ds_read_b64_tr_b16 v[60:61], v2 offset:30720
ds_read_b64_tr_b16 v[62:63], v2 offset:31232
v_mfma_f32_32x32x16_bf16 v[64:79], v[32:35], v[208:211], v[64:79]
v_mul_f32 v93, v93, v21
v_mul_f32 v94, v94, v22
v_mul_f32 v95, v95, v23
v_cvt_pk_bf16_f32 v30, v92, v93
v_cvt_pk_bf16_f32 v31, v94, v95
s_cmp_eq_u32 s19, 0
s_cbranch_scc1 L_ds4
buffer_store_dwordx4 v[24:27], v17, s[36:39], s50 offen offset:0 nt
L_dd4:
s_cmp_eq_u32 s19, 0
s_cbranch_scc1 L_ds5
buffer_store_dwordx4 v[28:31], v17, s[36:39], s50 offen offset:1024 nt
L_dd5:
s_waitcnt lgkmcnt(8)
v_mfma_f32_32x32x16_bf16 v[64:79], v[36:39], v[212:215], v[64:79]
ds_read_b64_tr_b16 v[32:33], v2 offset:32768
ds_read_b64_tr_b16 v[34:35], v2 offset:33280
ds_read_b64_tr_b16 v[36:37], v2 offset:34816
ds_read_b64_tr_b16 v[38:39], v2 offset:35328
v_mfma_f32_32x32x16_bf16 v[64:79], v[40:43], v[216:219], v[64:79]
s_add_u32 s50, s50, 8192
s_waitcnt lgkmcnt(8)
v_mfma_f32_32x32x16_bf16 v[64:79], v[44:47], v[220:223], v[64:79]
ds_read_b64_tr_b16 v[40:41], v2 offset:36864
ds_read_b64_tr_b16 v[42:43], v2 offset:37376
ds_read_b64_tr_b16 v[44:45], v2 offset:38912
ds_read_b64_tr_b16 v[46:47], v2 offset:39424
v_mfma_f32_32x32x16_bf16 v[64:79], v[48:51], v[224:227], v[64:79]
s_waitcnt lgkmcnt(8)
v_mfma_f32_32x32x16_bf16 v[64:79], v[52:55], v[228:231], v[64:79]
s_waitcnt lgkmcnt(0)
s_barrier
v_mfma_f32_32x32x16_bf16 v[64:79], v[56:59], v[232:235], v[64:79]
ds_read_b64_tr_b16 v[48:49], v4 offset:40960
ds_read_b64_tr_b16 v[50:51], v4 offset:41984
ds_read_b64_tr_b16 v[52:53], v4 offset:43008
ds_read_b64_tr_b16 v[54:55], v4 offset:44032
ds_read_b128 v[112:115], v14 offset:0
ds_read_b128 v[116:119], v14 offset:1024
v_mfma_f32_32x32x16_bf16 v[64:79], v[60:63], v[236:239], v[64:79]
ds_read_b64_tr_b16 v[56:57], v4 offset:45056
ds_read_b64_tr_b16 v[58:59], v4 offset:46080
ds_read_b64_tr_b16 v[60:61], v4 offset:47104
ds_read_b64_tr_b16 v[62:63], v4 offset:48128
v_mfma_f32_32x32x16_bf16 v[64:79], v[32:35], v[240:243], v[64:79]
ds_read_b128 v[120:123], v14 offset:2048
ds_read_b128 v[124:127], v14 offset:3072
v_mfma_f32_32x32x16_bf16 v[64:79], v[36:39], v[244:247], v[64:79]
ds_read_b64_tr_b16 v[32:33], v4 offset:49152
ds_read_b64_tr_b16 v[34:35], v4 offset:50176
ds_read_b64_tr_b16 v[36:37], v4 offset:51200
ds_read_b64_tr_b16 v[38:39], v4 offset:52224
v_mfma_f32_32x32x16_bf16 v[64:79], v[40:43], v[248:251], v[64:79]
ds_read_b128 v[128:131], v14 offset:8192
ds_read_b128 v[132:135], v14 offset:9216
v_mfma_f32_32x32x16_bf16 v[64:79], v[44:47], v[252:255], v[64:79]
ds_read_b64_tr_b16 v[40:41], v4 offset:53248
ds_read_b64_tr_b16 v[42:43], v4 offset:54272
ds_read_b64_tr_b16 v[44:45], v4 offset:55296
ds_read_b64_tr_b16 v[46:47], v4 offset:56320
s_waitcnt lgkmcnt(15)
v_mfma_f32_32x32x16_bf16 v[80:95], v[112:115], v[48:51], 0
ds_read_b128 v[136:139], v14 offset:10240
ds_read_b128 v[140:143], v14 offset:11264
v_mfma_f32_32x32x16_bf16 v[80:95], v[116:119], v[52:55], v[80:95]
ds_read_b64_tr_b16 v[48:49], v4 offset:57344
ds_read_b64_tr_b16 v[50:51], v4 offset:58368
ds_read_b64_tr_b16 v[52:53], v4 offset:59392
ds_read_b64_tr_b16 v[54:55], v4 offset:60416
s_waitcnt lgkmcnt(15)
v_mfma_f32_32x32x16_bf16 v[80:95], v[120:123], v[56:59], v[80:95]
ds_read_b128 v[144:147], v14 offset:16384
ds_read_b128 v[148:151], v14 offset:17408
v_mul_f32 v20, s51, v64
v_mul_f32 v21, s51, v65
v_mul_f32 v22, s51, v66
v_mul_f32 v23, s51, v67
v_exp_f32 v20, v20
v_exp_f32 v21, v21
v_exp_f32 v22, v22
v_exp_f32 v23, v23
s_waitcnt vmcnt(0)
s_mov_b64 exec, 1
s_cmp_eq_u32 s19, 0
s_cbranch_scc1 L_ds8
buffer_store_dwordx2 v[18:19], v1, s[36:39], 0 offen offset:32
L_dd8:
s_mov_b64 exec, -1
v_add_f32 v20, 1.0, v20
v_add_f32 v21, 1.0, v21
v_add_f32 v22, 1.0, v22
v_add_f32 v23, 1.0, v23
v_mfma_f32_32x32x16_bf16 v[80:95], v[124:127], v[60:63], v[80:95]
ds_read_b64_tr_b16 v[56:57], v4 offset:61440
ds_read_b64_tr_b16 v[58:59], v4 offset:62464
ds_read_b64_tr_b16 v[60:61], v4 offset:63488
ds_read_b64_tr_b16 v[62:63], v4 offset:64512
s_waitcnt lgkmcnt(15)
v_mfma_f32_32x32x16_bf16 v[80:95], v[128:131], v[32:35], v[80:95]
ds_read_b128 v[152:155], v14 offset:18432
ds_read_b128 v[156:159], v14 offset:19456
v_rcp_f32 v20, v20
v_rcp_f32 v21, v21
v_rcp_f32 v22, v22
v_rcp_f32 v23, v23
v_mul_f32 v64, v64, v20
v_mul_f32 v65, v65, v21
v_mul_f32 v66, v66, v22
v_mul_f32 v67, v67, v23
v_cvt_pk_bf16_f32 v24, v64, v65
v_cvt_pk_bf16_f32 v25, v66, v67
v_mul_f32 v20, s51, v68
v_mul_f32 v21, s51, v69
v_mul_f32 v22, s51, v70
v_mul_f32 v23, s51, v71
v_exp_f32 v20, v20
v_mfma_f32_32x32x16_bf16 v[80:95], v[132:135], v[36:39], v[80:95]
s_waitcnt lgkmcnt(0)
s_barrier
v_mfma_f32_32x32x16_bf16 v[80:95], v[136:139], v[40:43], v[80:95]
ds_read_b64_tr_b16 v[32:33], v5 offset:0
ds_read_b64_tr_b16 v[34:35], v5 offset:1024
ds_read_b64_tr_b16 v[36:37], v5 offset:2048
ds_read_b64_tr_b16 v[38:39], v5 offset:3072
v_mfma_f32_32x32x16_bf16 v[80:95], v[140:143], v[44:47], v[80:95]
ds_read_b64_tr_b16 v[40:41], v5 offset:4096
ds_read_b64_tr_b16 v[42:43], v5 offset:5120
ds_read_b64_tr_b16 v[44:45], v5 offset:6144
ds_read_b64_tr_b16 v[46:47], v5 offset:7168
v_mfma_f32_32x32x16_bf16 v[80:95], v[144:147], v[48:51], v[80:95]
v_exp_f32 v21, v21
v_exp_f32 v22, v22
v_exp_f32 v23, v23
v_add_f32 v20, 1.0, v20
v_add_f32 v21, 1.0, v21
v_add_f32 v22, 1.0, v22
v_add_f32 v23, 1.0, v23
v_rcp_f32 v20, v20
v_rcp_f32 v21, v21
v_rcp_f32 v22, v22
v_rcp_f32 v23, v23
v_mul_f32 v68, v68, v20
v_mul_f32 v69, v69, v21
v_mul_f32 v70, v70, v22
v_mul_f32 v71, v71, v23
v_cvt_pk_bf16_f32 v26, v68, v69
v_cvt_pk_bf16_f32 v27, v70, v71
v_mfma_f32_32x32x16_bf16 v[80:95], v[148:151], v[52:55], v[80:95]
ds_read_b64_tr_b16 v[48:49], v5 offset:8192
ds_read_b64_tr_b16 v[50:51], v5 offset:9216
ds_read_b64_tr_b16 v[52:53], v5 offset:10240
ds_read_b64_tr_b16 v[54:55], v5 offset:11264
v_mfma_f32_32x32x16_bf16 v[80:95], v[152:155], v[56:59], v[80:95]
s_cmp_eq_u32 s19, 0
s_cbranch_scc1 L_ds6
buffer_store_dwordx4 v[24:27], v17, s[36:39], s50 offen offset:0 nt
L_dd6:
v_mul_f32 v20, s51, v72
v_mul_f32 v21, s51, v73
v_mul_f32 v22, s51, v74
v_mul_f32 v23, s51, v75
v_exp_f32 v20, v20
v_exp_f32 v21, v21
v_exp_f32 v22, v22
v_exp_f32 v23, v23
v_add_f32 v20, 1.0, v20
v_add_f32 v21, 1.0, v21
v_add_f32 v22, 1.0, v22
v_add_f32 v23, 1.0, v23
v_rcp_f32 v20, v20
v_rcp_f32 v21, v21
v_rcp_f32 v22, v22
s_waitcnt lgkmcnt(8)
v_mfma_f32_32x32x16_bf16 v[80:95], v[156:159], v[60:63], v[80:95]
ds_read_b64_tr_b16 v[56:57], v5 offset:12288
ds_read_b64_tr_b16 v[58:59], v5 offset:13312
ds_read_b64_tr_b16 v[60:61], v5 offset:14336
ds_read_b64_tr_b16 v[62:63], v5 offset:15360
v_mfma_f32_32x32x16_bf16 v[96:111], v[112:115], v[32:35], 0
v_rcp_f32 v23, v23
v_mul_f32 v72, v72, v20
v_mul_f32 v73, v73, v21
v_mul_f32 v74, v74, v22
v_mul_f32 v75, v75, v23
v_cvt_pk_bf16_f32 v28, v72, v73
v_cvt_pk_bf16_f32 v29, v74, v75
v_mul_f32 v20, s51, v76
v_mul_f32 v21, s51, v77
v_mul_f32 v22, s51, v78
v_mul_f32 v23, s51, v79
v_exp_f32 v20, v20
v_exp_f32 v21, v21
v_exp_f32 v22, v22
v_exp_f32 v23, v23
v_add_f32 v20, 1.0, v20
v_add_f32 v21, 1.0, v21
v_add_f32 v22, 1.0, v22
v_add_f32 v23, 1.0, v23
v_rcp_f32 v20, v20
s_waitcnt lgkmcnt(8)
v_mfma_f32_32x32x16_bf16 v[96:111], v[116:119], v[36:39], v[96:111]
ds_read_b64_tr_b16 v[32:33], v5 offset:16384
ds_read_b64_tr_b16 v[34:35], v5 offset:17408
ds_read_b64_tr_b16 v[36:37], v5 offset:18432
ds_read_b64_tr_b16 v[38:39], v5 offset:19456
v_mfma_f32_32x32x16_bf16 v[96:111], v[120:123], v[40:43], v[96:111]
v_rcp_f32 v21, v21
v_rcp_f32 v22, v22
v_rcp_f32 v23, v23
v_mul_f32 v76, v76, v20
v_mul_f32 v77, v77, v21
v_mul_f32 v78, v78, v22
v_mul_f32 v79, v79, v23
v_cvt_pk_bf16_f32 v30, v76, v77
v_cvt_pk_bf16_f32 v31, v78, v79
s_cmp_eq_u32 s19, 0
s_cbranch_scc1 L_ds7
buffer_store_dwordx4 v[28:31], v17, s[36:39], s50 offen offset:1024 nt
L_dd7:
v_and_b32 v7, 31, v0
v_lshrrev_b32 v6, 5, v0
v_lshlrev_b32 v7, 4, v7
v_mul_u32_u24 v6, 589824, v6
v_add_u32 v7, v7, v6
v_mul_u32_u24 v6, 9216, v0
v_add_u32 v6, s54, v6
s_waitcnt lgkmcnt(8)
v_mfma_f32_32x32x16_bf16 v[96:111], v[124:127], v[44:47], v[96:111]
ds_read_b64_tr_b16 v[40:41], v5 offset:20480
ds_read_b64_tr_b16 v[42:43], v5 offset:21504
ds_read_b64_tr_b16 v[44:45], v5 offset:22528
ds_read_b64_tr_b16 v[46:47], v5 offset:23552
v_mfma_f32_32x32x16_bf16 v[96:111], v[128:131], v[48:51], v[96:111]
s_waitcnt lgkmcnt(8)
v_mfma_f32_32x32x16_bf16 v[96:111], v[132:135], v[52:55], v[96:111]
s_waitcnt lgkmcnt(0)
s_barrier
v_mfma_f32_32x32x16_bf16 v[96:111], v[136:139], v[56:59], v[96:111]
ds_read_b64_tr_b16 v[48:49], v4 offset:0
ds_read_b64_tr_b16 v[50:51], v4 offset:1024
ds_read_b64_tr_b16 v[52:53], v4 offset:2048
ds_read_b64_tr_b16 v[54:55], v4 offset:3072
v_mfma_f32_32x32x16_bf16 v[96:111], v[140:143], v[60:63], v[96:111]
ds_read_b64_tr_b16 v[56:57], v4 offset:4096
ds_read_b64_tr_b16 v[58:59], v4 offset:5120
ds_read_b64_tr_b16 v[60:61], v4 offset:6144
ds_read_b64_tr_b16 v[62:63], v4 offset:7168
v_mfma_f32_32x32x16_bf16 v[96:111], v[144:147], v[32:35], v[96:111]
v_mfma_f32_32x32x16_bf16 v[96:111], v[148:151], v[36:39], v[96:111]
ds_read_b64_tr_b16 v[32:33], v4 offset:8192
ds_read_b64_tr_b16 v[34:35], v4 offset:9216
ds_read_b64_tr_b16 v[36:37], v4 offset:10240
ds_read_b64_tr_b16 v[38:39], v4 offset:11264
v_mfma_f32_32x32x16_bf16 v[96:111], v[152:155], v[40:43], v[96:111]
s_waitcnt vmcnt(0)
s_mov_b64 exec, 1
s_cmp_eq_u32 s19, 0
s_cbranch_scc1 L_ds9
buffer_store_dwordx2 v[18:19], v1, s[36:39], 0 offen offset:64
L_dd9:
s_mov_b64 exec, -1
s_waitcnt lgkmcnt(8)
v_mfma_f32_32x32x16_bf16 v[96:111], v[156:159], v[44:47], v[96:111]
ds_read_b64_tr_b16 v[40:41], v4 offset:12288
ds_read_b64_tr_b16 v[42:43], v4 offset:13312
ds_read_b64_tr_b16 v[44:45], v4 offset:14336
ds_read_b64_tr_b16 v[46:47], v4 offset:15360
v_mfma_f32_32x32x16_bf16 v[64:79], v[112:115], v[48:51], 0
s_waitcnt lgkmcnt(8)
v_mfma_f32_32x32x16_bf16 v[64:79], v[116:119], v[52:55], v[64:79]
ds_read_b64_tr_b16 v[48:49], v4 offset:16384
ds_read_b64_tr_b16 v[50:51], v4 offset:17408
ds_read_b64_tr_b16 v[52:53], v4 offset:18432
ds_read_b64_tr_b16 v[54:55], v4 offset:19456
v_mfma_f32_32x32x16_bf16 v[64:79], v[120:123], v[56:59], v[64:79]
s_waitcnt lgkmcnt(8)
v_mfma_f32_32x32x16_bf16 v[64:79], v[124:127], v[60:63], v[64:79]
ds_read_b64_tr_b16 v[56:57], v4 offset:20480
ds_read_b64_tr_b16 v[58:59], v4 offset:21504
ds_read_b64_tr_b16 v[60:61], v4 offset:22528
ds_read_b64_tr_b16 v[62:63], v4 offset:23552
v_mfma_f32_32x32x16_bf16 v[64:79], v[128:131], v[32:35], v[64:79]
s_waitcnt lgkmcnt(8)
v_mfma_f32_32x32x16_bf16 v[64:79], v[132:135], v[36:39], v[64:79]
s_waitcnt lgkmcnt(0)
s_barrier
v_mfma_f32_32x32x16_bf16 v[64:79], v[136:139], v[40:43], v[64:79]
ds_read_b64_tr_b16 v[32:33], v4 offset:24576
ds_read_b64_tr_b16 v[34:35], v4 offset:25600
ds_read_b64_tr_b16 v[36:37], v4 offset:26624
ds_read_b64_tr_b16 v[38:39], v4 offset:27648
ds_read_b128 v[160:163], v14 offset:24576
ds_read_b128 v[164:167], v14 offset:25600
v_mfma_f32_32x32x16_bf16 v[64:79], v[140:143], v[44:47], v[64:79]
ds_read_b64_tr_b16 v[40:41], v4 offset:28672
ds_read_b64_tr_b16 v[42:43], v4 offset:29696
ds_read_b64_tr_b16 v[44:45], v4 offset:30720
ds_read_b64_tr_b16 v[46:47], v4 offset:31744
v_mfma_f32_32x32x16_bf16 v[64:79], v[144:147], v[48:51], v[64:79]
ds_read_b128 v[168:171], v14 offset:26624
ds_read_b128 v[172:175], v14 offset:27648
v_mfma_f32_32x32x16_bf16 v[64:79], v[148:151], v[52:55], v[64:79]
ds_read_b64_tr_b16 v[48:49], v4 offset:32768
ds_read_b64_tr_b16 v[50:51], v4 offset:33792
ds_read_b64_tr_b16 v[52:53], v4 offset:34816
ds_read_b64_tr_b16 v[54:55], v4 offset:35840
v_mfma_f32_32x32x16_bf16 v[64:79], v[152:155], v[56:59], v[64:79]
ds_read_b128 v[176:179], v14 offset:32768
ds_read_b128 v[180:183], v14 offset:33792
v_mfma_f32_32x32x16_bf16 v[64:79], v[156:159], v[60:63], v[64:79]
ds_read_b64_tr_b16 v[56:57], v4 offset:36864
ds_read_b64_tr_b16 v[58:59], v4 offset:37888
ds_read_b64_tr_b16 v[60:61], v4 offset:38912
ds_read_b64_tr_b16 v[62:63], v4 offset:39936
s_waitcnt lgkmcnt(15)
v_mfma_f32_32x32x16_bf16 v[80:95], v[160:163], v[32:35], v[80:95]
ds_read_b128 v[184:187], v14 offset:34816
ds_read_b128 v[188:191], v14 offset:35840
v_mfma_f32_32x32x16_bf16 v[80:95], v[164:167], v[36:39], v[80:95]
ds_read_b64_tr_b16 v[32:33], v4 offset:40960
ds_read_b64_tr_b16 v[34:35], v4 offset:41984
ds_read_b64_tr_b16 v[36:37], v4 offset:43008
ds_read_b64_tr_b16 v[38:39], v4 offset:44032
s_waitcnt lgkmcnt(15)
v_mfma_f32_32x32x16_bf16 v[80:95], v[168:171], v[40:43], v[80:95]
ds_read_b128 v[192:195], v14 offset:40960
ds_read_b128 v[196:199], v14 offset:41984
v_mfma_f32_32x32x16_bf16 v[80:95], v[172:175], v[44:47], v[80:95]
ds_read_b64_tr_b16 v[40:41], v4 offset:45056
ds_read_b64_tr_b16 v[42:43], v4 offset:46080
ds_read_b64_tr_b16 v[44:45], v4 offset:47104
ds_read_b64_tr_b16 v[46:47], v4 offset:48128
s_waitcnt lgkmcnt(15)
v_mfma_f32_32x32x16_bf16 v[80:95], v[176:179], v[48:51], v[80:95]
ds_read_b128 v[200:203], v14 offset:43008
ds_read_b128 v[204:207], v14 offset:44032
v_mfma_f32_32x32x16_bf16 v[80:95], v[180:183], v[52:55], v[80:95]
s_waitcnt lgkmcnt(0)
s_barrier
v_mfma_f32_32x32x16_bf16 v[80:95], v[184:187], v[56:59], v[80:95]
ds_read_b64_tr_b16 v[48:49], v4 offset:49152
ds_read_b64_tr_b16 v[50:51], v4 offset:50176
ds_read_b64_tr_b16 v[52:53], v4 offset:51200
ds_read_b64_tr_b16 v[54:55], v4 offset:52224
v_mfma_f32_32x32x16_bf16 v[80:95], v[188:191], v[60:63], v[80:95]
ds_read_b64_tr_b16 v[56:57], v4 offset:53248
ds_read_b64_tr_b16 v[58:59], v4 offset:54272
ds_read_b64_tr_b16 v[60:61], v4 offset:55296
ds_read_b64_tr_b16 v[62:63], v4 offset:56320
v_mfma_f32_32x32x16_bf16 v[80:95], v[192:195], v[32:35], v[80:95]
v_mfma_f32_32x32x16_bf16 v[80:95], v[196:199], v[36:39], v[80:95]
ds_read_b64_tr_b16 v[32:33], v4 offset:57344
ds_read_b64_tr_b16 v[34:35], v4 offset:58368
ds_read_b64_tr_b16 v[36:37], v4 offset:59392
ds_read_b64_tr_b16 v[38:39], v4 offset:60416
v_mfma_f32_32x32x16_bf16 v[80:95], v[200:203], v[40:43], v[80:95]
s_waitcnt lgkmcnt(8)
v_mfma_f32_32x32x16_bf16 v[80:95], v[204:207], v[44:47], v[80:95]
ds_read_b64_tr_b16 v[40:41], v4 offset:61440
ds_read_b64_tr_b16 v[42:43], v4 offset:62464
ds_read_b64_tr_b16 v[44:45], v4 offset:63488
ds_read_b64_tr_b16 v[46:47], v4 offset:64512
v_mfma_f32_32x32x16_bf16 v[96:111], v[160:163], v[48:51], v[96:111]
s_waitcnt lgkmcnt(8)
v_mfma_f32_32x32x16_bf16 v[96:111], v[164:167], v[52:55], v[96:111]
ds_read_b64_tr_b16 v[48:49], v5 offset:0
ds_read_b64_tr_b16 v[50:51], v5 offset:1024
ds_read_b64_tr_b16 v[52:53], v5 offset:2048
ds_read_b64_tr_b16 v[54:55], v5 offset:3072
v_mfma_f32_32x32x16_bf16 v[96:111], v[168:171], v[56:59], v[96:111]
s_waitcnt lgkmcnt(8)
v_mfma_f32_32x32x16_bf16 v[96:111], v[172:175], v[60:63], v[96:111]
ds_read_b64_tr_b16 v[56:57], v5 offset:4096
ds_read_b64_tr_b16 v[58:59], v5 offset:5120
ds_read_b64_tr_b16 v[60:61], v5 offset:6144
ds_read_b64_tr_b16 v[62:63], v5 offset:7168
v_mfma_f32_32x32x16_bf16 v[96:111], v[176:179], v[32:35], v[96:111]
s_waitcnt lgkmcnt(8)
v_mfma_f32_32x32x16_bf16 v[96:111], v[180:183], v[36:39], v[96:111]
s_waitcnt lgkmcnt(0)
s_barrier
v_mfma_f32_32x32x16_bf16 v[96:111], v[184:187], v[40:43], v[96:111]
ds_read_b64_tr_b16 v[32:33], v5 offset:8192
ds_read_b64_tr_b16 v[34:35], v5 offset:9216
ds_read_b64_tr_b16 v[36:37], v5 offset:10240
ds_read_b64_tr_b16 v[38:39], v5 offset:11264
ds_read_b128 v[208:211], v14 offset:49152
ds_read_b128 v[212:215], v14 offset:50176
v_mfma_f32_32x32x16_bf16 v[96:111], v[188:191], v[44:47], v[96:111]
ds_read_b64_tr_b16 v[40:41], v5 offset:12288
ds_read_b64_tr_b16 v[42:43], v5 offset:13312
ds_read_b64_tr_b16 v[44:45], v5 offset:14336
ds_read_b64_tr_b16 v[46:47], v5 offset:15360
v_mfma_f32_32x32x16_bf16 v[96:111], v[192:195], v[48:51], v[96:111]
ds_read_b128 v[216:219], v14 offset:51200
ds_read_b128 v[220:223], v14 offset:52224
v_mfma_f32_32x32x16_bf16 v[96:111], v[196:199], v[52:55], v[96:111]
ds_read_b64_tr_b16 v[48:49], v5 offset:16384
ds_read_b64_tr_b16 v[50:51], v5 offset:17408
ds_read_b64_tr_b16 v[52:53], v5 offset:18432
ds_read_b64_tr_b16 v[54:55], v5 offset:19456
v_mfma_f32_32x32x16_bf16 v[96:111], v[200:203], v[56:59], v[96:111]
ds_read_b128 v[224:227], v14 offset:57344
ds_read_b128 v[228:231], v14 offset:58368
v_mfma_f32_32x32x16_bf16 v[96:111], v[204:207], v[60:63], v[96:111]
ds_read_b64_tr_b16 v[56:57], v5 offset:20480
ds_read_b64_tr_b16 v[58:59], v5 offset:21504
ds_read_b64_tr_b16 v[60:61], v5 offset:22528
ds_read_b64_tr_b16 v[62:63], v5 offset:23552
s_waitcnt lgkmcnt(15)
v_mfma_f32_32x32x16_bf16 v[80:95], v[208:211], v[32:35], v[80:95]
ds_read_b128 v[232:235], v14 offset:59392
ds_read_b128 v[236:239], v14 offset:60416
v_mfma_f32_32x32x16_bf16 v[80:95], v[212:215], v[36:39], v[80:95]
ds_read_b64_tr_b16 v[32:33], v4 offset:0
ds_read_b64_tr_b16 v[34:35], v4 offset:1024
ds_read_b64_tr_b16 v[36:37], v4 offset:2048
ds_read_b64_tr_b16 v[38:39], v4 offset:3072
s_waitcnt lgkmcnt(15)
v_mfma_f32_32x32x16_bf16 v[80:95], v[216:219], v[40:43], v[80:95]
ds_read_b128 v[240:243], v15 offset:0
ds_read_b128 v[244:247], v15 offset:1024
v_mfma_f32_32x32x16_bf16 v[80:95], v[220:223], v[44:47], v[80:95]
ds_read_b64_tr_b16 v[40:41], v4 offset:4096
ds_read_b64_tr_b16 v[42:43], v4 offset:5120
ds_read_b64_tr_b16 v[44:45], v4 offset:6144
ds_read_b64_tr_b16 v[46:47], v4 offset:7168
s_waitcnt lgkmcnt(15)
v_mfma_f32_32x32x16_bf16 v[80:95], v[224:227], v[48:51], v[80:95]
ds_read_b128 v[248:251], v15 offset:2048
ds_read_b128 v[252:255], v15 offset:3072
v_mfma_f32_32x32x16_bf16 v[80:95], v[228:231], v[52:55], v[80:95]
s_waitcnt lgkmcnt(0)
s_barrier
v_mfma_f32_32x32x16_bf16 v[80:95], v[232:235], v[56:59], v[80:95]
ds_read_b64_tr_b16 v[48:49], v4 offset:8192
ds_read_b64_tr_b16 v[50:51], v4 offset:9216
ds_read_b64_tr_b16 v[52:53], v4 offset:10240
ds_read_b64_tr_b16 v[54:55], v4 offset:11264
v_mfma_f32_32x32x16_bf16 v[80:95], v[236:239], v[60:63], v[80:95]
ds_read_b64_tr_b16 v[56:57], v4 offset:12288
ds_read_b64_tr_b16 v[58:59], v4 offset:13312
ds_read_b64_tr_b16 v[60:61], v4 offset:14336
ds_read_b64_tr_b16 v[62:63], v4 offset:15360
v_mfma_f32_32x32x16_bf16 v[80:95], v[240:243], v[32:35], v[80:95]
v_mfma_f32_32x32x16_bf16 v[80:95], v[244:247], v[36:39], v[80:95]
ds_read_b64_tr_b16 v[32:33], v4 offset:16384
ds_read_b64_tr_b16 v[34:35], v4 offset:17408
ds_read_b64_tr_b16 v[36:37], v4 offset:18432
ds_read_b64_tr_b16 v[38:39], v4 offset:19456
v_mfma_f32_32x32x16_bf16 v[80:95], v[248:251], v[40:43], v[80:95]
s_waitcnt lgkmcnt(8)
v_mfma_f32_32x32x16_bf16 v[80:95], v[252:255], v[44:47], v[80:95]
ds_read_b64_tr_b16 v[40:41], v4 offset:20480
ds_read_b64_tr_b16 v[42:43], v4 offset:21504
ds_read_b64_tr_b16 v[44:45], v4 offset:22528
ds_read_b64_tr_b16 v[46:47], v4 offset:23552
v_mfma_f32_32x32x16_bf16 v[96:111], v[208:211], v[48:51], v[96:111]
s_waitcnt lgkmcnt(8)
v_mfma_f32_32x32x16_bf16 v[96:111], v[212:215], v[52:55], v[96:111]
ds_read_b64_tr_b16 v[48:49], v4 offset:24576
ds_read_b64_tr_b16 v[50:51], v4 offset:25600
ds_read_b64_tr_b16 v[52:53], v4 offset:26624
ds_read_b64_tr_b16 v[54:55], v4 offset:27648
v_mfma_f32_32x32x16_bf16 v[96:111], v[216:219], v[56:59], v[96:111]
s_waitcnt lgkmcnt(8)
v_mfma_f32_32x32x16_bf16 v[96:111], v[220:223], v[60:63], v[96:111]
ds_read_b64_tr_b16 v[56:57], v4 offset:28672
ds_read_b64_tr_b16 v[58:59], v4 offset:29696
ds_read_b64_tr_b16 v[60:61], v4 offset:30720
ds_read_b64_tr_b16 v[62:63], v4 offset:31744
v_mfma_f32_32x32x16_bf16 v[96:111], v[224:227], v[32:35], v[96:111]
v_cvt_pk_bf16_f32 v24, v80, v81
v_cvt_pk_bf16_f32 v25, v82, v83
v_cvt_pk_bf16_f32 v26, v84, v85
v_cvt_pk_bf16_f32 v27, v86, v87
v_cvt_pk_bf16_f32 v28, v88, v89
v_cvt_pk_bf16_f32 v29, v90, v91
s_waitcnt lgkmcnt(8)
v_mfma_f32_32x32x16_bf16 v[96:111], v[228:231], v[36:39], v[96:111]
s_waitcnt lgkmcnt(0)
s_barrier
v_mfma_f32_32x32x16_bf16 v[96:111], v[232:235], v[40:43], v[96:111]
ds_read_b64_tr_b16 v[32:33], v4 offset:32768
ds_read_b64_tr_b16 v[34:35], v4 offset:33792
ds_read_b64_tr_b16 v[36:37], v4 offset:34816
ds_read_b64_tr_b16 v[38:39], v4 offset:35840
v_mfma_f32_32x32x16_bf16 v[96:111], v[236:239], v[44:47], v[96:111]
ds_read_b64_tr_b16 v[40:41], v4 offset:36864
ds_read_b64_tr_b16 v[42:43], v4 offset:37888
ds_read_b64_tr_b16 v[44:45], v4 offset:38912
ds_read_b64_tr_b16 v[46:47], v4 offset:39936
v_mfma_f32_32x32x16_bf16 v[96:111], v[240:243], v[48:51], v[96:111]
v_cvt_pk_bf16_f32 v30, v92, v93
v_cvt_pk_bf16_f32 v31, v94, v95
s_nop 0
v_permlane32_swap_b32 v24, v26
v_permlane32_swap_b32 v25, v27
v_permlane32_swap_b32 v28, v30
v_mfma_f32_32x32x16_bf16 v[96:111], v[244:247], v[52:55], v[96:111]
ds_read_b64_tr_b16 v[48:49], v4 offset:40960
ds_read_b64_tr_b16 v[50:51], v4 offset:41984
ds_read_b64_tr_b16 v[52:53], v4 offset:43008
ds_read_b64_tr_b16 v[54:55], v4 offset:44032
v_mfma_f32_32x32x16_bf16 v[96:111], v[248:251], v[56:59], v[96:111]
v_permlane32_swap_b32 v29, v31
buffer_store_dwordx4 v[24:27], v7, s[36:39], s52 offen offset:0 sc1
s_waitcnt lgkmcnt(8)
v_mfma_f32_32x32x16_bf16 v[96:111], v[252:255], v[60:63], v[96:111]
ds_read_b64_tr_b16 v[56:57], v4 offset:45056
ds_read_b64_tr_b16 v[58:59], v4 offset:46080
ds_read_b64_tr_b16 v[60:61], v4 offset:47104
ds_read_b64_tr_b16 v[62:63], v4 offset:48128
v_mfma_f32_32x32x16_bf16 v[64:79], v[160:163], v[32:35], v[64:79]
buffer_store_dwordx4 v[28:31], v7, s[36:39], s53 offen offset:0 sc1
s_nop 0
s_waitcnt lgkmcnt(8)
v_mfma_f32_32x32x16_bf16 v[64:79], v[164:167], v[36:39], v[64:79]
ds_read_b64_tr_b16 v[32:33], v4 offset:49152
ds_read_b64_tr_b16 v[34:35], v4 offset:50176
ds_read_b64_tr_b16 v[36:37], v4 offset:51200
ds_read_b64_tr_b16 v[38:39], v4 offset:52224
v_mfma_f32_32x32x16_bf16 v[64:79], v[168:171], v[40:43], v[64:79]
s_waitcnt lgkmcnt(8)
v_mfma_f32_32x32x16_bf16 v[64:79], v[172:175], v[44:47], v[64:79]
ds_read_b64_tr_b16 v[40:41], v4 offset:53248
ds_read_b64_tr_b16 v[42:43], v4 offset:54272
ds_read_b64_tr_b16 v[44:45], v4 offset:55296
ds_read_b64_tr_b16 v[46:47], v4 offset:56320
v_mfma_f32_32x32x16_bf16 v[64:79], v[176:179], v[48:51], v[64:79]
v_cvt_pk_bf16_f32 v24, v96, v97
v_cvt_pk_bf16_f32 v25, v98, v99
v_cvt_pk_bf16_f32 v26, v100, v101
v_cvt_pk_bf16_f32 v27, v102, v103
v_cvt_pk_bf16_f32 v28, v104, v105
v_cvt_pk_bf16_f32 v29, v106, v107
s_waitcnt lgkmcnt(8)
v_mfma_f32_32x32x16_bf16 v[64:79], v[180:183], v[52:55], v[64:79]
s_waitcnt lgkmcnt(0)
s_barrier
v_mfma_f32_32x32x16_bf16 v[64:79], v[184:187], v[56:59], v[64:79]
ds_read_b64_tr_b16 v[48:49], v4 offset:57344
ds_read_b64_tr_b16 v[50:51], v4 offset:58368
ds_read_b64_tr_b16 v[52:53], v4 offset:59392
ds_read_b64_tr_b16 v[54:55], v4 offset:60416
v_mfma_f32_32x32x16_bf16 v[64:79], v[188:191], v[60:63], v[64:79]
ds_read_b64_tr_b16 v[56:57], v4 offset:61440
ds_read_b64_tr_b16 v[58:59], v4 offset:62464
ds_read_b64_tr_b16 v[60:61], v4 offset:63488
ds_read_b64_tr_b16 v[62:63], v4 offset:64512
v_mfma_f32_32x32x16_bf16 v[64:79], v[192:195], v[32:35], v[64:79]
v_cvt_pk_bf16_f32 v30, v108, v109
v_cvt_pk_bf16_f32 v31, v110, v111
s_nop 0
v_permlane32_swap_b32 v24, v26
v_permlane32_swap_b32 v25, v27
v_permlane32_swap_b32 v28, v30
v_mfma_f32_32x32x16_bf16 v[64:79], v[196:199], v[36:39], v[64:79]
ds_read_b64_tr_b16 v[32:33], v5 offset:0
ds_read_b64_tr_b16 v[34:35], v5 offset:1024
ds_read_b64_tr_b16 v[36:37], v5 offset:2048
ds_read_b64_tr_b16 v[38:39], v5 offset:3072
v_mfma_f32_32x32x16_bf16 v[64:79], v[200:203], v[40:43], v[64:79]
v_permlane32_swap_b32 v29, v31
buffer_store_dwordx4 v[24:27], v7, s[36:39], s52 offen offset:1024 sc1
s_waitcnt lgkmcnt(8)
v_mfma_f32_32x32x16_bf16 v[64:79], v[204:207], v[44:47], v[64:79]
ds_read_b64_tr_b16 v[40:41], v5 offset:4096
ds_read_b64_tr_b16 v[42:43], v5 offset:5120
ds_read_b64_tr_b16 v[44:45], v5 offset:6144
ds_read_b64_tr_b16 v[46:47], v5 offset:7168
v_mfma_f32_32x32x16_bf16 v[64:79], v[208:211], v[48:51], v[64:79]
buffer_store_dwordx4 v[28:31], v7, s[36:39], s53 offen offset:1024 sc1
s_nop 0
s_waitcnt lgkmcnt(8)
v_mfma_f32_32x32x16_bf16 v[64:79], v[212:215], v[52:55], v[64:79]
ds_read_b64_tr_b16 v[48:49], v5 offset:8192
ds_read_b64_tr_b16 v[50:51], v5 offset:9216
ds_read_b64_tr_b16 v[52:53], v5 offset:10240
ds_read_b64_tr_b16 v[54:55], v5 offset:11264
v_mfma_f32_32x32x16_bf16 v[64:79], v[216:219], v[56:59], v[64:79]
s_waitcnt lgkmcnt(8)
v_mfma_f32_32x32x16_bf16 v[64:79], v[220:223], v[60:63], v[64:79]
ds_read_b64_tr_b16 v[56:57], v5 offset:12288
ds_read_b64_tr_b16 v[58:59], v5 offset:13312
ds_read_b64_tr_b16 v[60:61], v5 offset:14336
ds_read_b64_tr_b16 v[62:63], v5 offset:15360
v_mfma_f32_32x32x16_bf16 v[64:79], v[224:227], v[32:35], v[64:79]
s_waitcnt lgkmcnt(8)
v_mfma_f32_32x32x16_bf16 v[64:79], v[228:231], v[36:39], v[64:79]
v_mfma_f32_32x32x16_bf16 v[64:79], v[232:235], v[40:43], v[64:79]
s_waitcnt lgkmcnt(4)
v_mfma_f32_32x32x16_bf16 v[64:79], v[236:239], v[44:47], v[64:79]
v_mfma_f32_32x32x16_bf16 v[64:79], v[240:243], v[48:51], v[64:79]
s_waitcnt lgkmcnt(0)
v_mfma_f32_32x32x16_bf16 v[64:79], v[244:247], v[52:55], v[64:79]
v_mfma_f32_32x32x16_bf16 v[64:79], v[248:251], v[56:59], v[64:79]
v_mfma_f32_32x32x16_bf16 v[64:79], v[252:255], v[60:63], v[64:79]
s_nop 7
s_nop 3
v_cvt_pk_bf16_f32 v24, v64, v65
v_cvt_pk_bf16_f32 v25, v66, v67
v_cvt_pk_bf16_f32 v26, v68, v69
v_cvt_pk_bf16_f32 v27, v70, v71
v_cvt_pk_bf16_f32 v28, v72, v73
v_cvt_pk_bf16_f32 v29, v74, v75
v_cvt_pk_bf16_f32 v30, v76, v77
v_cvt_pk_bf16_f32 v31, v78, v79
s_nop 0
v_permlane32_swap_b32 v24, v26
v_permlane32_swap_b32 v25, v27
v_permlane32_swap_b32 v28, v30
v_permlane32_swap_b32 v29, v31
buffer_store_dwordx4 v[24:27], v7, s[36:39], s52 offen offset:2048 sc1
buffer_store_dwordx4 v[28:31], v7, s[36:39], s53 offen offset:2048 sc1
s_nop 0
s_mov_b32 s60, 0
s_waitcnt vmcnt(4)
s_mov_b64 exec, 0xf
buffer_store_dwordx2 v[18:19], v6, s[36:39], s60 offen sc1
s_mov_b64 exec, -1
s_mov_b32 s60, 128
s_waitcnt vmcnt(3)
s_mov_b64 exec, 0xf
buffer_store_dwordx2 v[18:19], v6, s[36:39], s60 offen sc1
s_mov_b64 exec, -1
s_mov_b32 s60, 256
s_waitcnt vmcnt(2)
s_mov_b64 exec, 0xf
buffer_store_dwordx2 v[18:19], v6, s[36:39], s60 offen sc1
s_mov_b64 exec, -1
s_endpgm
L_gather:
s_cmp_eq_u32 s17, 7
s_cbranch_scc1 L_end
s_and_b32 s48, s17, 3
s_cmp_lt_u32 s17, 4
s_cselect_b32 s57, 1, 0
s_mul_i32 s3, s18, 384
s_min_u32 s50, s48, 2
s_mul_i32 s50, s50, 128
s_add_u32 s3, s3, s50
s_add_u32 s3, s3, 65536
v_mul_u32_u24 v4, 8, v0
v_add_u32 v4, s3, v4
v_lshlrev_b32 v5, 4, v0
v_mov_b32 v2, s20
v_mov_b32 v3, s21
s_mul_i32 s52, s18, 24576
s_lshl_b32 s53, s48, 10
s_add_u32 s52, s52, s53
s_add_u32 s52, s52, 5242880
v_lshlrev_b32 v6, 1, v0
s_lshl_b32 s50, s15, 6
s_lshl_b32 s51, s14, 3
s_add_u32 s50, s50, s51
s_mul_i32 s50, s50, 1152
s_mul_i32 s51, s16, 384
s_add_u32 s50, s50, s51
s_lshl_b32 s51, s48, 7
s_add_u32 s50, s50, s51
s_add_u32 s53, s50, 4608
s_mov_b32 s54, 0xffff0000
s_mov_b64 exec, 0xffff
s_mov_b32 s46, 1000000
L_poll_p:
buffer_load_dwordx2 v[40:41], v4, s[36:39], 0 offen offset:0 sc1
s_waitcnt vmcnt(0)
v_cmp_ne_u64 vcc, v[40:41], v[2:3]
s_sub_u32 s46, s46, 1
s_cmp_eq_u32 s46, 0
s_cbranch_scc1 L_polldone_p
s_nop 1
s_cbranch_vccz L_polldone_p
s_sleep 1
s_branch L_poll_p
L_polldone_p:
s_mov_b64 exec, -1
buffer_load_dwordx4 v[8:11], v5, s[36:39], s52 offen sc1
s_add_u32 s52, s52, 3072
buffer_load_dwordx4 v[12:15], v5, s[36:39], s52 offen sc1
s_add_u32 s52, s52, 3072
buffer_load_dwordx4 v[16:19], v5, s[36:39], s52 offen sc1
s_add_u32 s52, s52, 3072
buffer_load_dwordx4 v[20:23], v5, s[36:39], s52 offen sc1
s_add_u32 s52, s52, 3072
buffer_load_dwordx4 v[24:27], v5, s[36:39], s52 offen sc1
s_add_u32 s52, s52, 3072
buffer_load_dwordx4 v[28:31], v5, s[36:39], s52 offen sc1
s_add_u32 s52, s52, 3072
buffer_load_dwordx4 v[32:35], v5, s[36:39], s52 offen sc1
s_add_u32 s52, s52, 3072
buffer_load_dwordx4 v[36:39], v5, s[36:39], s52 offen sc1
s_or_b32 s51, s14, s16
s_or_b32 s51, s51, s48
s_or_b32 s51, s51, s57
s_cmp_lg_u32 s51, 0
s_cbranch_scc1 L_noepoch
s_lshl_b32 s51, s15, 7
v_mov_b32 v4, s51
s_mov_b64 exec, 1
buffer_store_dwordx2 v[2:3], v4, s[36:39], 0 offen sc1
s_mov_b64 exec, -1
s_waitcnt vmcnt(0)
L_noepoch:
s_waitcnt vmcnt(7)
v_lshlrev_b32 v44, 16, v8
v_and_b32 v45, s54, v8
v_lshlrev_b32 v46, 16, v9
v_and_b32 v47, s54, v9
v_lshlrev_b32 v48, 16, v10
v_and_b32 v49, s54, v10
v_lshlrev_b32 v50, 16, v11
v_and_b32 v51, s54, v11
s_waitcnt vmcnt(6)
v_lshlrev_b32 v52, 16, v12
v_and_b32 v53, s54, v12
v_add_f32 v44, v44, v52
v_add_f32 v45, v45, v53
v_lshlrev_b32 v52, 16, v13
v_and_b32 v53, s54, v13
v_add_f32 v46, v46, v52
v_add_f32 v47, v47, v53
v_lshlrev_b32 v52, 16, v14
v_and_b32 v53, s54, v14
v_add_f32 v48, v48, v52
v_add_f32 v49, v49, v53
v_lshlrev_b32 v52, 16, v15
v_and_b32 v53, s54, v15
v_add_f32 v50, v50, v52
v_add_f32 v51, v51, v53
s_waitcnt vmcnt(5)
v_lshlrev_b32 v52, 16, v16
v_and_b32 v53, s54, v16
v_add_f32 v44, v44, v52
v_add_f32 v45, v45, v53
v_lshlrev_b32 v52, 16, v17
v_and_b32 v53, s54, v17
v_add_f32 v46, v46, v52
v_add_f32 v47, v47, v53
v_lshlrev_b32 v52, 16, v18
v_and_b32 v53, s54, v18
v_add_f32 v48, v48, v52
v_add_f32 v49, v49, v53
v_lshlrev_b32 v52, 16, v19
v_and_b32 v53, s54, v19
v_add_f32 v50, v50, v52
v_add_f32 v51, v51, v53
s_waitcnt vmcnt(4)
v_lshlrev_b32 v52, 16, v20
v_and_b32 v53, s54, v20
v_add_f32 v44, v44, v52
v_add_f32 v45, v45, v53
v_lshlrev_b32 v52, 16, v21
v_and_b32 v53, s54, v21
v_add_f32 v46, v46, v52
v_add_f32 v47, v47, v53
v_lshlrev_b32 v52, 16, v22
v_and_b32 v53, s54, v22
v_add_f32 v48, v48, v52
v_add_f32 v49, v49, v53
v_lshlrev_b32 v52, 16, v23
v_and_b32 v53, s54, v23
v_add_f32 v50, v50, v52
v_add_f32 v51, v51, v53
s_waitcnt vmcnt(3)
v_lshlrev_b32 v52, 16, v24
v_and_b32 v53, s54, v24
v_add_f32 v44, v44, v52
v_add_f32 v45, v45, v53
v_lshlrev_b32 v52, 16, v25
v_and_b32 v53, s54, v25
v_add_f32 v46, v46, v52
v_add_f32 v47, v47, v53
v_lshlrev_b32 v52, 16, v26
v_and_b32 v53, s54, v26
v_add_f32 v48, v48, v52
v_add_f32 v49, v49, v53
v_lshlrev_b32 v52, 16, v27
v_and_b32 v53, s54, v27
v_add_f32 v50, v50, v52
v_add_f32 v51, v51, v53
s_waitcnt vmcnt(2)
v_lshlrev_b32 v52, 16, v28
v_and_b32 v53, s54, v28
v_add_f32 v44, v44, v52
v_add_f32 v45, v45, v53
v_lshlrev_b32 v52, 16, v29
v_and_b32 v53, s54, v29
v_add_f32 v46, v46, v52
v_add_f32 v47, v47, v53
v_lshlrev_b32 v52, 16, v30
v_and_b32 v53, s54, v30
v_add_f32 v48, v48, v52
v_add_f32 v49, v49, v53
v_lshlrev_b32 v52, 16, v31
v_and_b32 v53, s54, v31
v_add_f32 v50, v50, v52
v_add_f32 v51, v51, v53
s_waitcnt vmcnt(1)
v_lshlrev_b32 v52, 16, v32
v_and_b32 v53, s54, v32
v_add_f32 v44, v44, v52
v_add_f32 v45, v45, v53
v_lshlrev_b32 v52, 16, v33
v_and_b32 v53, s54, v33
v_add_f32 v46, v46, v52
v_add_f32 v47, v47, v53
v_lshlrev_b32 v52, 16, v34
v_and_b32 v53, s54, v34
v_add_f32 v48, v48, v52
v_add_f32 v49, v49, v53
v_lshlrev_b32 v52, 16, v35
v_and_b32 v53, s54, v35
v_add_f32 v50, v50, v52
v_add_f32 v51, v51, v53
s_waitcnt vmcnt(0)
v_lshlrev_b32 v52, 16, v36
v_and_b32 v53, s54, v36
v_add_f32 v44, v44, v52
v_add_f32 v45, v45, v53
v_lshlrev_b32 v52, 16, v37
v_and_b32 v53, s54, v37
v_add_f32 v46, v46, v52
v_add_f32 v47, v47, v53
v_lshlrev_b32 v52, 16, v38
v_and_b32 v53, s54, v38
v_add_f32 v48, v48, v52
v_add_f32 v49, v49, v53
v_lshlrev_b32 v52, 16, v39
v_and_b32 v53, s54, v39
v_add_f32 v50, v50, v52
v_add_f32 v51, v51, v53
v_cvt_pk_bf16_f32 v8, v44, v45
v_cvt_pk_bf16_f32 v9, v46, v47
v_cvt_pk_bf16_f32 v10, v48, v49
v_cvt_pk_bf16_f32 v11, v50, v51
buffer_store_short v8, v6, s[40:43], s50 offen offset:0
buffer_store_short_d16_hi v8, v6, s[40:43], s50 offen offset:1152
buffer_store_short v9, v6, s[40:43], s50 offen offset:2304
buffer_store_short_d16_hi v9, v6, s[40:43], s50 offen offset:3456
buffer_store_short v10, v6, s[40:43], s53 offen offset:0
buffer_store_short_d16_hi v10, v6, s[40:43], s53 offen offset:1152
buffer_store_short v11, v6, s[40:43], s53 offen offset:2304
buffer_store_short_d16_hi v11, v6, s[40:43], s53 offen offset:3456
s_endpgm
L_ds1:
buffer_store_dwordx4 v[24:27], v17, s[36:39], s50 offen offset:0 sc1
s_branch L_dd1
L_ds2:
buffer_store_dwordx4 v[28:31], v17, s[36:39], s50 offen offset:1024 sc1
s_branch L_dd2
L_ds3:
buffer_store_dwordx2 v[18:19], v1, s[36:39], 0 offen offset:0 sc1
s_branch L_dd3
L_ds4:
buffer_store_dwordx4 v[24:27], v17, s[36:39], s50 offen offset:0 sc1
s_branch L_dd4
L_ds5:
buffer_store_dwordx4 v[28:31], v17, s[36:39], s50 offen offset:1024 sc1
s_branch L_dd5
L_ds6:
buffer_store_dwordx4 v[24:27], v17, s[36:39], s50 offen offset:0 sc1
s_branch L_dd6
L_ds7:
buffer_store_dwordx4 v[28:31], v17, s[36:39], s50 offen offset:1024 sc1
s_branch L_dd7
L_ds8:
buffer_store_dwordx2 v[18:19], v1, s[36:39], 0 offen offset:32 sc1
s_branch L_dd8
L_ds9:
buffer_store_dwordx2 v[18:19], v1, s[36:39], 0 offen offset:64 sc1
s_branch L_dd9
L_end:
s_endpgm
.section .rodata,"a"
.p2align 6
.amdhsa_kernel standalone__dense_activation_silu__sampling_kernel
  .amdhsa_next_free_vgpr 256
  .amdhsa_next_free_sgpr 72
  .amdhsa_accum_offset 256
  .amdhsa_group_segment_fixed_size 0
  .amdhsa_kernarg_size 48
  .amdhsa_user_sgpr_count 2
  .amdhsa_user_sgpr_kernarg_segment_ptr 1
  .amdhsa_system_sgpr_workgroup_id_x 1
.end_amdhsa_kernel
```
